```python
import torch

def _softmax(x, axis=-1):
    return torch.softmax(x, dim=axis)
def _gelu(x):
    return torch.nn.functional.gelu(x, approximate="tanh")
def _silu(x):
    return torch.nn.functional.silu(x)
def _sigmoid(x):
    return torch.sigmoid(x)
def _layernorm(x, axis=-1, eps=1e-5):
    m = x.mean(dim=axis, keepdim=True)
    v = x.var(dim=axis, keepdim=True, unbiased=False)
    return (x - m) / torch.sqrt(v + eps)
def _scatter_add(tgt, idx, src, axis=0):
    return tgt.clone().index_add_(axis, idx, src)
def _segment_sum(src, seg, n):
    out = torch.zeros((n,) + src.shape[1:], dtype=src.dtype)
    return out.index_add_(0, seg, src)
def _pad(x, pw):
    flat = tuple(v for pair in reversed(pw) for v in pair)
    return torch.nn.functional.pad(x, flat)

kernel_name = 'gated_mix__ssm_conv_s5__glu_gated_geglu__prompt'

def setup_inputs():

    _w = (lambda a: (lambda t: t.to(torch.bfloat16) if t.is_floating_point() else t)(torch.as_tensor(a)))
    def _A_setup():
        B, S, D = 1, 2048, 512
        P = D
        Lambda_re = -0.5 * (lambda _x: torch.exp(torch.as_tensor(_x)))((lambda *s: torch.randn(*s, dtype=torch.bfloat16) * 0.2)(P))
        Lambda_im = (lambda *s: torch.randn(*s, dtype=torch.bfloat16) * 0.4)(P) * 1.0
        B_re = (lambda *s: torch.randn(*s, dtype=torch.bfloat16) * 0.2)(P, D) * (D ** -0.5)
        B_im = (lambda *s: torch.randn(*s, dtype=torch.bfloat16) * 0.2)(P, D) * (D ** -0.5)
        C_re = (lambda *s: torch.randn(*s, dtype=torch.bfloat16) * 0.2)(D, P) * (P ** -0.5)
        C_im = (lambda *s: torch.randn(*s, dtype=torch.bfloat16) * 0.2)(D, P) * (P ** -0.5)
        log_dt = (lambda *s: torch.randn(*s, dtype=torch.bfloat16) * 0.2)(P) * 0.3 - 2.0
        Dskip = (lambda *s: torch.randn(*s, dtype=torch.bfloat16) * 0.05)(D)
        return {
            "x": _w((lambda *s: torch.randn(*s, dtype=torch.bfloat16) * 0.05)(B, S, D)),
            "Lambda_re": _w(Lambda_re),
            "Lambda_im": _w(Lambda_im),
            "B_re": _w(B_re),
            "B_im": _w(B_im),
            "C_re": _w(C_re),
            "C_im": _w(C_im),
            "log_dt": _w(log_dt),
            "Dskip": _w(Dskip),
        }
    _A_in = _A_setup()

    def _B_setup():
        B, S, Dm, Df = 1, 2048, 512, 1792
        return {
            "x": _w((lambda *s: torch.randn(*s, dtype=torch.bfloat16) * 0.05)(B, S, Dm)),
            "w_gate": _w((lambda *s: torch.randn(*s, dtype=torch.bfloat16) * 1.6)(Dm, Df) * (Dm ** -0.5)),
            "w_up": _w((lambda *s: torch.randn(*s, dtype=torch.bfloat16) * 1.6)(Dm, Df) * (Dm ** -0.5)),
            "w_down": _w((lambda *s: torch.randn(*s, dtype=torch.bfloat16) * 1.6)(Df, Dm) * (Df ** -0.5)),
        }
    _B_in = _B_setup()

    return {
        "A_x": _A_in["x"],
        "A_Lambda_re": _A_in["Lambda_re"],
        "A_Lambda_im": _A_in["Lambda_im"],
        "A_B_re": _A_in["B_re"],
        "A_B_im": _A_in["B_im"],
        "A_C_re": _A_in["C_re"],
        "A_C_im": _A_in["C_im"],
        "A_log_dt": _A_in["log_dt"],
        "A_Dskip": _A_in["Dskip"],
        "B_x": _B_in["x"],
        "B_w_gate": _B_in["w_gate"],
        "B_w_up": _B_in["w_up"],
        "B_w_down": _B_in["w_down"],
        "gate_w": _w((lambda *s: torch.randn(*s, dtype=torch.bfloat16) * 0.05)(512) * 16.0),
    }

def reference(A_x, A_Lambda_re, A_Lambda_im, A_B_re, A_B_im, A_C_re, A_C_im, A_log_dt, A_Dskip, B_x, B_w_gate, B_w_up, B_w_down, gate_w):
    def _A_ref(x, Lambda_re, Lambda_im, B_re, B_im, C_re, C_im, log_dt, Dskip):
        Bsz, L, H = x.shape
        Lam = Lambda_re + 1j * Lambda_im
        Bmat = B_re + 1j * B_im
        Cmat = C_re + 1j * C_im
        dt = torch.exp(log_dt)
        Lam_bar = torch.exp(dt * Lam)
        B_bar = ((Lam_bar - 1.0) / Lam)[:, None] * Bmat
        Bu = torch.einsum("bld,pd->blp", x + 0j, B_bar)
        h = torch.zeros_like(Bu[:, 0, :])
        hs = []
        for t in range(L):
            h = Lam_bar[None, :] * h + Bu[:, t, :]
            hs.append(h)
        hseq = torch.stack(hs, 1)
        y = 2.0 * torch.einsum("blp,dp->bld", hseq, Cmat).real + x * Dskip[None, None, :]
        return y

    def _B_ref(x, w_gate, w_up, w_down):
        g = torch.einsum("bsd,df->bsf", x, w_gate)
        u = torch.einsum("bsd,df->bsf", x, w_up)
        h = _gelu(g) * u
        return torch.einsum("bsf,fd->bsd", h, w_down)

    x = A_x
    g = _sigmoid((x * gate_w).sum(-1, keepdims=True))
    a = _A_ref(x, A_Lambda_re, A_Lambda_im, A_B_re, A_B_im, A_C_re, A_C_im, A_log_dt, A_Dskip)
    b = _B_ref(x, B_w_gate, B_w_up, B_w_down)
    return g * a + (1 - g) * b
```

```asm
; @launch grid=(256,1,1) block=(256,1,1) lds=163840
.amdgcn_target "amdgcn-amd-amdhsa--gfx950"
.text
.globl gated_mix__ssm_conv_s5__glu_gated_geglu__prompt_kernel
.p2align 8
.type gated_mix__ssm_conv_s5__glu_gated_geglu__prompt_kernel,@function
gated_mix__ssm_conv_s5__glu_gated_geglu__prompt_kernel:

    s_cmp_ge_u32 s2, 256
    s_cbranch_scc1 gated_mix__ssm_conv_s5__glu_gated_geglu__prompt_kernel_end
    s_load_dwordx2 s[4:5], s[0:1], 0
    s_load_dwordx2 s[8:9], s[0:1], 24
    s_load_dwordx2 s[12:13], s[0:1], 32
    s_load_dwordx2 s[16:17], s[0:1], 80
    s_load_dwordx2 s[20:21], s[0:1], 88
    s_load_dwordx4 s[32:35], s[0:1], 8
    s_load_dwordx4 s[36:39], s[0:1], 40
    s_load_dwordx4 s[40:43], s[0:1], 56
    s_load_dwordx4 s[44:47], s[0:1], 96
    s_load_dwordx2 s[28:29], s[0:1], 120
    s_load_dwordx2 s[24:25], s[0:1], 128
    s_load_dwordx2 s[88:89], s[0:1], 112
    s_getpc_b64 s[60:61]
gated_mix__ssm_conv_s5__glu_gated_geglu__prompt_kernel_pcref:
    v_lshrrev_b32 v216, 6, v0
    v_and_b32 v218, 1, v0
    v_lshl_add_u32 v216, v216, 1, v218
    s_lshr_b32 s62, s2, 3
    s_lshl_b32 s62, s62, 3
    v_add_u32 v216, s62, v216
    v_lshlrev_b32 v216, 7, v216
    v_mov_b32 v217, gated_mix__ssm_conv_s5__glu_gated_geglu__prompt_kernel_codeend-gated_mix__ssm_conv_s5__glu_gated_geglu__prompt_kernel_pcref-16
    v_min_u32 v216, v216, v217
    global_load_dword v220, v216, s[60:61]
    v_and_b32 v1, 63, v0
    v_lshrrev_b32 v217, 6, v0
    s_and_b32 s62, s2, 7
    v_readfirstlane_b32 s50, v217
    s_lshr_b32 s63, s2, 3
    s_lshr_b32 s48, s62, 2
    s_lshl_b32 s48, s48, 3
    s_and_b32 s49, s63, 7
    s_add_u32 s48, s48, s49
    s_and_b32 s49, s62, 3
    s_lshl_b32 s49, s49, 2
    s_lshr_b32 s82, s63, 3
    s_add_u32 s49, s49, s82
    s_and_b32 s83, s62, 1
    s_lshr_b32 s81, s62, 1
    s_lshl_b32 s81, s81, 2
    s_and_b32 s82, s63, 3
    s_add_u32 s81, s81, s82
    s_lshr_b32 s82, s63, 2
    s_and_b32 s51, s50, 1
    s_lshr_b32 s52, s50, 1
    v_lshrrev_b32 v61, 5, v1
    v_and_b32 v62, 31, v1
    v_bfe_u32 v224, v1, 3, 2
    v_lshl_add_u32 v224, v61, 4, v224
    v_lshlrev_b32 v224, 10, v224
    v_lshrrev_b32 v225, 4, v1
    v_and_b32 v226, 7, v1
    v_xor_b32 v227, v226, v225
    v_xor_b32 v2, 0, v227
    v_lshl_add_u32 v2, v2, 4, v224
    v_xor_b32 v3, 4, v227
    v_lshl_add_u32 v3, v3, 4, v224
    v_add_u32 v3, 3072, v3
    v_xor_b32 v4, 0, v227
    v_lshl_add_u32 v4, v4, 4, v224
    v_add_u32 v4, 6144, v4
    v_xor_b32 v5, 4, v227
    v_lshl_add_u32 v5, v5, 4, v224
    v_add_u32 v5, 9216, v5
    s_lshl_b32 s62, s51, 2
    v_xor_b32 v6, s62, v227
    v_lshrrev_b32 v224, 3, v1
    v_lshlrev_b32 v224, 10, v224
    v_lshl_add_u32 v6, v6, 4, v224
    v_lshrrev_b32 v224, 2, v1
    v_mul_u32_u24 v224, 3584, v224
    v_and_b32 v225, 3, v1
    v_lshl_add_u32 v7, v225, 4, v224
    v_xor_b32 v225, 2, v225
    v_lshl_add_u32 v8, v225, 4, v224
    s_lshl_b32 s53, s48, 17
    s_lshl_b32 s62, s50, 15
    s_add_u32 s53, s53, s62
    s_lshl_b32 s54, s49, 15
    s_lshl_b32 s62, s50, 13
    s_add_u32 s54, s54, s62
    s_lshr_b32 s62, s49, 2
    s_mul_i32 s62, s62, 28
    s_and_b32 s61, s49, 3
    s_lshl_b32 s63, s61, 2
    s_add_u32 s80, s62, s63
    s_lshl_b32 s61, s61, 3
    s_add_u32 s62, s62, 16
    s_lshr_b32 s63, 0x0a060400, s61
    s_and_b32 s63, s63, 0xff
    s_add_u32 s90, s62, s63
    s_lshr_b32 s63, 0x09080302, s61
    s_and_b32 s63, s63, 0xff
    s_add_u32 s91, s62, s63
    s_mul_i32 s55, s50, 57344
    s_lshl_b32 s63, s90, 5
    s_add_u32 s55, s55, s63
    s_and_b32 s64, s48, 7
    s_mul_i32 s56, s51, 114688
    s_lshl_b32 s63, s80, 5
    s_add_u32 s56, s56, s63
    s_lshl_b32 s57, s91, 5
    s_lshl_b32 s58, s50, 12
    s_add_u32 s59, s58, 16384
    s_waitcnt lgkmcnt(0)
    s_mov_b32 s6, 2097152
    s_mov_b32 s7, 0x20000
    s_mov_b32 s10, 524288
    s_mov_b32 s11, 0x20000
    s_sub_u32 s12, s12, 1024
    s_subb_u32 s13, s13, 0
    s_mov_b32 s14, 525312
    s_mov_b32 s15, 0x20000
    s_sub_u32 s16, s16, 2048
    s_subb_u32 s17, s17, 0
    s_mov_b32 s18, 1837056
    s_mov_b32 s19, 0x20000
    s_sub_u32 s20, s20, 3072
    s_subb_u32 s21, s21, 0
    s_mov_b32 s22, 1838080
    s_mov_b32 s23, 0x20000
    s_add_u32 s92, s64, 0
    s_and_b32 s92, s92, 7
    s_mul_i32 s93, s92, 229376
    s_lshl_b32 s92, s92, 7
    s_add_u32 m0, s58, 0
    s_add_u32 s98, s53, s92
    buffer_load_dwordx4 v2, s[4:7], s98 offen lds
    buffer_load_dwordx4 v3, s[4:7], s98 offen offset:1024 lds
    buffer_load_dwordx4 v4, s[4:7], s98 offen offset:2048 lds
    buffer_load_dwordx4 v5, s[4:7], s98 offen offset:3072 lds
    s_add_u32 m0, s59, 0
    s_add_u32 s98, s54, s92
    buffer_load_dwordx4 v6, s[8:11], s98 offen lds
    buffer_load_dwordx4 v6, s[12:15], s98 offen offset:1024 lds
    s_add_u32 s98, s55, s93
    buffer_load_dwordx4 v7, s[16:19], s98 offen offset:2048 lds
    buffer_load_dwordx4 v8, s[20:23], s98 offen offset:3072 lds
    v_bfe_u32 v224, v62, 1, 3
    v_xor_b32 v224, v224, v61
    v_lshlrev_b32 v224, 4, v224
    v_lshl_add_u32 v224, v62, 7, v224
    s_lshl_b32 s62, s50, 12
    s_xor_b32 s63, s62, 4096
    v_lshrrev_b32 v226, 3, v62
    v_mul_u32_u24 v226, 3072, v226
    v_add_u32 v226, 0x4000, v226
    v_xor_b32 v225, 0, v224
    v_add_u32 v17, s62, v225
    v_add_u32 v21, s63, v225
    v_add_u32 v25, v225, v226
    v_xor_b32 v225, 32, v224
    v_add_u32 v18, s62, v225
    v_add_u32 v22, s63, v225
    v_add_u32 v26, v225, v226
    v_xor_b32 v225, 64, v224
    v_add_u32 v19, s62, v225
    v_add_u32 v23, s63, v225
    v_add_u32 v27, v225, v226
    v_xor_b32 v225, 96, v224
    v_add_u32 v20, s62, v225
    v_add_u32 v24, s63, v225
    v_add_u32 v28, v225, v226
    s_add_u32 s92, s64, 1
    s_and_b32 s92, s92, 7
    s_mul_i32 s93, s92, 229376
    s_lshl_b32 s92, s92, 7
    s_add_u32 m0, s58, 32768
    s_add_u32 s98, s53, s92
    buffer_load_dwordx4 v2, s[4:7], s98 offen lds
    buffer_load_dwordx4 v3, s[4:7], s98 offen offset:1024 lds
    buffer_load_dwordx4 v4, s[4:7], s98 offen offset:2048 lds
    buffer_load_dwordx4 v5, s[4:7], s98 offen offset:3072 lds
    s_add_u32 m0, s59, 32768
    s_add_u32 s98, s54, s92
    buffer_load_dwordx4 v6, s[8:11], s98 offen lds
    buffer_load_dwordx4 v6, s[12:15], s98 offen offset:1024 lds
    s_add_u32 s98, s55, s93
    buffer_load_dwordx4 v7, s[16:19], s98 offen offset:2048 lds
    buffer_load_dwordx4 v8, s[20:23], s98 offen offset:3072 lds
    v_bfe_u32 v244, v1, 4, 1
    v_and_b32 v245, 15, v1
    v_lshrrev_b32 v246, 2, v245
    v_lshl_add_u32 v246, v61, 3, v246
    v_and_b32 v225, 3, v245
    v_lshlrev_b32 v225, 3, v225
    v_xor_b32 v226, s51, v244
    v_lshl_add_u32 v225, v226, 5, v225
    v_lshl_add_u32 v247, v246, 6, v225
    v_lshlrev_b32 v227, 10, v244
    v_add_u32 v29, v247, v227
    v_add_u32 v29, 0x4800, v29
    s_add_u32 s92, s64, 2
    s_and_b32 s92, s92, 7
    s_mul_i32 s93, s92, 229376
    s_lshl_b32 s92, s92, 7
    s_add_u32 m0, s58, 65536
    s_add_u32 s98, s53, s92
    buffer_load_dwordx4 v2, s[4:7], s98 offen lds
    buffer_load_dwordx4 v3, s[4:7], s98 offen offset:1024 lds
    buffer_load_dwordx4 v4, s[4:7], s98 offen offset:2048 lds
    buffer_load_dwordx4 v5, s[4:7], s98 offen offset:3072 lds
    s_add_u32 m0, s59, 65536
    s_add_u32 s98, s54, s92
    buffer_load_dwordx4 v6, s[8:11], s98 offen lds
    buffer_load_dwordx4 v6, s[12:15], s98 offen offset:1024 lds
    s_add_u32 s98, s55, s93
    buffer_load_dwordx4 v7, s[16:19], s98 offen offset:2048 lds
    buffer_load_dwordx4 v8, s[20:23], s98 offen offset:3072 lds
    s_mov_b32 s26, 67108864
    s_mov_b32 s27, 0x20000
    s_mov_b32 s30, 256
    s_mov_b32 s31, 0x20000
    s_mov_b32 s99, 0
    s_or_b32 s60, s2, s50
    s_cmp_eq_u32 s60, 0
    s_cbranch_scc0 gated_mix__ssm_conv_s5__glu_gated_geglu__prompt_kernel_nononce
    s_memrealtime s[60:61]
    s_waitcnt lgkmcnt(0)
    s_or_b32 s60, s60, 1
    v_mov_b32 v224, 0
    v_mov_b32 v225, s60
    buffer_store_dword v225, v224, s[28:31], 0 offen sc1
gated_mix__ssm_conv_s5__glu_gated_geglu__prompt_kernel_nononce:
    s_lshl_b32 s62, s49, 6
    v_lshl_add_u32 v53, v62, 1, s62
    global_load_ushort v128, v53, s[32:33]
    global_load_ushort v129, v53, s[34:35]
    global_load_ushort v130, v53, s[40:41]
    v_lshlrev_b32 v60, 4, v1
    v_bfe_u32 v228, v245, 3, 1
    v_lshlrev_b32 v228, 1, v228
    v_xor_b32 v228, v228, v244
    v_xor_b32 v228, s51, v228
    v_and_b32 v229, 3, v245
    v_lshlrev_b32 v229, 3, v229
    v_lshl_add_u32 v229, v228, 5, v229
    v_lshl_add_u32 v229, v246, 7, v229
    v_lshl_add_u32 v30, v244, 14, v229
    v_xor_b32 v47, 64, v30
    v_and_b32 v229, 3, v245
    v_lshlrev_b32 v229, 3, v229
    v_lshl_add_u32 v229, v246, 5, v229
    v_lshl_add_u32 v229, v244, 14, v229
    v_add_u32 v229, 131072, v229
    v_lshl_add_u32 v31, v244, 7, v229
    v_xor_b32 v230, 1, v244
    v_lshl_add_u32 v32, v230, 7, v229
    v_lshrrev_b32 v228, 3, v1
    v_mul_u32_u24 v228, 3584, v228
    v_and_b32 v229, 1, v1
    v_lshl_add_u32 v228, v229, 4, v228
    v_bfe_u32 v229, v1, 1, 2
    v_bfe_u32 v230, v1, 4, 1
    v_lshlrev_b32 v230, 1, v230
    v_xor_b32 v229, v229, v230
    v_lshl_add_u32 v9, v229, 5, v228
    v_xor_b32 v13, 32, v9
    v_add_u32 v10, 27648, v9
    v_add_u32 v14, 27648, v13
    v_add_u32 v11, 55296, v9
    v_add_u32 v15, 55296, v13
    v_add_u32 v12, 82944, v9
    v_add_u32 v16, 82944, v13
    s_mov_b32 s100, 0x7ffffff0
    s_lshl_b32 s62, s50, 9
    s_mul_i32 s63, s52, 15360
    s_add_u32 s62, s62, s63
    s_add_u32 s62, s62, 146432
    v_lshlrev_b32 v228, 3, v62
    v_lshl_add_u32 v45, v61, 8, v228
    v_add_u32 v45, s62, v45
    v_add_u32 v46, 146432, v228
    s_lshl_b32 s62, s50, 12
    s_add_u32 s61, s62, 0
    v_lshlrev_b32 v228, 2, v62
    v_lshl_add_u32 v49, v61, 11, v228
    v_add_u32 v49, s61, v49
    v_bfe_u32 v228, v62, 2, 1
    v_lshlrev_b32 v228, 4, v228
    v_lshrrev_b32 v229, 3, v62
    v_lshl_add_u32 v228, v229, 2, v228
    v_and_b32 v229, 3, v62
    v_add_u32 v228, v228, v229
    v_bfe_u32 v229, v228, 1, 3
    v_xor_b32 v229, v229, v61
    v_lshlrev_b32 v229, 4, v229
    v_lshl_add_u32 v50, v228, 7, v229
    s_lshl_b32 s62, s50, 12
    s_add_u32 s62, s62, 0
    v_add_u32 v50, s62, v50
    s_lshl_b32 s87, s48, 1
    s_add_u32 s87, s87, s52
    s_mul_i32 s87, s87, 360448
    s_lshl_b32 s60, s51, 10
    s_xor_b32 s61, s60, 1024
    s_add_u32 s62, s90, s51
    s_lshl_b32 s62, s62, 11
    s_add_u32 s62, s62, s87
    s_add_u32 s62, s62, 131072
    s_add_u32 s84, s62, s60
    s_add_u32 s85, s62, s61
    s_add_u32 s62, s80, s51
    s_lshl_b32 s62, s62, 11
    s_add_u32 s62, s62, s87
    s_add_u32 s62, s62, 131072
    s_add_u32 s94, s62, s60
    s_add_u32 s95, s62, s61
    s_lshl_b32 s62, s91, 11
    s_add_u32 s62, s62, s87
    s_add_u32 s62, s62, 131072
    s_add_u32 s86, s62, s60
    s_lshl_b32 s62, s49, 13
    s_add_u32 s87, s87, s62
    s_add_u32 s87, s87, s60
    s_lshl_b32 s62, s48, 4
    s_add_u32 s62, s62, s49
    s_lshl_b32 s62, s62, 9
    s_add_u32 s62, s62, 15794176
    v_lshlrev_b32 v228, 3, v1
    v_add_u32 v228, s62, v228
    v_cmp_gt_u32 vcc, 64, v0
    v_mov_b32 v229, s100
    s_nop 0
    v_cndmask_b32 v51, v229, v228, vcc
    s_lshl_b32 s62, s50, 1
    v_add_u32 v228, s62, v61
    v_cmp_eq_u32 s[66:67], 1, v228
    v_cmp_eq_u32 s[68:69], 2, v228
    v_cmp_eq_u32 s[70:71], 3, v228
    v_cmp_eq_u32 s[72:73], 4, v228
    v_cmp_eq_u32 s[74:75], 5, v228
    v_cmp_eq_u32 s[76:77], 6, v228
    v_cmp_eq_u32 s[78:79], 7, v228
    v_mov_b32 v48, 0xc0135761
    s_lshl_b32 s62, s48, 7
    s_lshl_b32 s63, s49, 3
    s_add_u32 s62, s62, s63
    s_lshl_b32 s63, s50, 1
    s_add_u32 s62, s62, s63
    s_lshl_b32 s63, s62, 2
    s_add_u32 s63, s63, 15728640
    v_mov_b32 v52, s63
    s_lshl_b32 s62, s62, 10
    v_add_u32 v228, s62, v60
    global_load_dwordx4 v[132:135], v228, s[4:5]
    global_load_dwordx4 v[136:139], v228, s[4:5] offset:1024
    global_load_dwordx4 v[140:143], v60, s[46:47]
    s_cmp_ge_u32 s50, 2
    s_cselect_b32 s32, s38, s36
    s_cselect_b32 s33, s39, s37
    s_mov_b32 s34, 524288
    s_mov_b32 s35, 0x20000
    v_lshrrev_b32 v53, 2, v1
    v_lshlrev_b32 v53, 10, v53
    v_and_b32 v54, 3, v1
    v_lshl_add_u32 v53, v54, 4, v53
    s_lshl_b32 s62, s48, 15
    s_lshl_b32 s63, s51, 14
    s_add_u32 s62, s62, s63
    s_lshl_b32 s63, s49, 6
    s_add_u32 s62, s62, s63
    s_add_u32 m0, s58, 133120
    s_nop 0
    buffer_load_dwordx4 v53, s[32:35], s62 offen lds
    s_mov_b32 s32, s44
    s_mov_b32 s33, s45
    s_mov_b32 s34, 1835008
    s_mov_b32 s35, 0x20000
    v_lshrrev_b32 v53, 2, v1
    v_lshlrev_b32 v53, 10, v53
    v_and_b32 v54, 3, v1
    v_lshl_add_u32 v53, v54, 4, v53
    s_mul_i32 s62, s49, 7
    s_add_u32 s62, s62, s50
    s_lshl_b32 s62, s62, 14
    s_lshl_b32 s63, s48, 6
    s_add_u32 s62, s62, s63
    s_add_u32 m0, s58, 131072
    s_nop 0
    buffer_load_dwordx4 v53, s[32:35], s62 offen lds
    s_add_u32 s63, s50, 4
    s_min_u32 s63, s63, 6
    s_sub_u32 s63, s63, s50
    s_lshl_b32 s63, s63, 14
    s_add_u32 s62, s62, s63
    s_add_u32 m0, s58, 132096
    s_nop 0
    buffer_load_dwordx4 v53, s[32:35], s62 offen lds
    s_waitcnt vmcnt(25)
    s_barrier
    ds_read_b128 a[0:3], v17 offset:0
    ds_read_b128 v[160:163], v25 offset:0
    ds_read_b128 v[172:175], v25 offset:1024
    ds_read_b64_tr_b16 v[192:193], v29 offset:0
    ds_read_b64_tr_b16 v[194:195], v29 offset:256
    ds_read_b128 a[128:131], v21 offset:0
    s_waitcnt lgkmcnt(0)
    v_mfma_f32_32x32x16_bf16 v[64:79], a[0:3], v[160:163], 0
    ds_read_b128 a[4:7], v18 offset:0
    ds_read_b128 v[164:167], v26 offset:0
    ds_read_b128 v[176:179], v26 offset:1024
    s_add_u32 s92, s64, 3
    s_and_b32 s92, s92, 7
    s_mul_i32 s93, s92, 229376
    s_lshl_b32 s92, s92, 7
    s_add_u32 m0, s58, 98304
    s_add_u32 s98, s53, s92
    buffer_load_dwordx4 v2, s[4:7], s98 offen lds
    v_mfma_f32_32x32x16_bf16 v[80:95], a[0:3], v[172:175], 0
    ds_read_b64_tr_b16 v[196:197], v29 offset:4096
    ds_read_b64_tr_b16 v[198:199], v29 offset:4352
    ds_read_b128 a[132:135], v22 offset:0
    v_mfma_f32_32x32x16_bf16 v[96:111], v[192:195], a[0:3], 0
    ds_read_b128 a[8:11], v19 offset:0
    ds_read_b128 v[168:171], v27 offset:0
    ds_read_b128 v[180:183], v27 offset:1024
    buffer_load_dwordx4 v3, s[4:7], s98 offen offset:1024 lds
    v_mfma_f32_32x32x16_bf16 v[112:127], v[192:195], a[128:131], 0
    ds_read_b64_tr_b16 v[200:201], v29 offset:8192
    ds_read_b64_tr_b16 v[202:203], v29 offset:8448
    ds_read_b128 a[136:139], v23 offset:0
    s_waitcnt lgkmcnt(6)
    v_mfma_f32_32x32x16_bf16 v[64:79], a[4:7], v[164:167], v[64:79]
    ds_read_b128 a[12:15], v20 offset:0
    ds_read_b128 v[160:163], v28 offset:0
    buffer_load_dwordx4 v4, s[4:7], s98 offen offset:2048 lds
    v_mfma_f32_32x32x16_bf16 v[80:95], a[4:7], v[176:179], v[80:95]
    ds_read_b128 v[172:175], v28 offset:1024
    ds_read_b64_tr_b16 v[192:193], v29 offset:12288
    v_mfma_f32_32x32x16_bf16 v[96:111], v[196:199], a[4:7], v[96:111]
    ds_read_b64_tr_b16 v[194:195], v29 offset:12544
    buffer_load_dwordx4 v5, s[4:7], s98 offen offset:3072 lds
    v_mfma_f32_32x32x16_bf16 v[112:127], v[196:199], a[132:135], v[112:127]
    ds_read_b128 a[140:143], v24 offset:0
    s_waitcnt lgkmcnt(6)
    v_mfma_f32_32x32x16_bf16 v[64:79], a[8:11], v[168:171], v[64:79]
    s_add_u32 m0, s59, 98304
    s_add_u32 s98, s54, s92
    buffer_load_dwordx4 v6, s[8:11], s98 offen lds
    v_mfma_f32_32x32x16_bf16 v[80:95], a[8:11], v[180:183], v[80:95]
    s_waitcnt lgkmcnt(0)
    s_waitcnt vmcnt(22)
    s_barrier
    ds_read_b128 a[16:19], v17 offset:32768
    ds_read_b128 v[164:167], v25 offset:32768
    v_mfma_f32_32x32x16_bf16 v[96:111], v[200:203], a[8:11], v[96:111]
    ds_read_b128 v[176:179], v25 offset:33792
    ds_read_b64_tr_b16 v[196:197], v29 offset:32768
    buffer_load_dwordx4 v6, s[12:15], s98 offen offset:1024 lds
    v_mfma_f32_32x32x16_bf16 v[112:127], v[200:203], a[136:139], v[112:127]
    ds_read_b64_tr_b16 v[198:199], v29 offset:33024
    ds_read_b128 a[144:147], v21 offset:32768
    v_mfma_f32_32x32x16_bf16 v[64:79], a[12:15], v[160:163], v[64:79]
    ds_read_b128 a[20:23], v18 offset:32768
    ds_read_b128 v[168:171], v26 offset:32768
    s_add_u32 s98, s55, s93
    buffer_load_dwordx4 v7, s[16:19], s98 offen offset:2048 lds
    v_mfma_f32_32x32x16_bf16 v[80:95], a[12:15], v[172:175], v[80:95]
    ds_read_b128 v[180:183], v26 offset:33792
    ds_read_b64_tr_b16 v[200:201], v29 offset:36864
    v_mfma_f32_32x32x16_bf16 v[96:111], v[192:195], a[12:15], v[96:111]
    ds_read_b64_tr_b16 v[202:203], v29 offset:37120
    buffer_load_dwordx4 v8, s[20:23], s98 offen offset:3072 lds
    v_mfma_f32_32x32x16_bf16 v[112:127], v[192:195], a[140:143], v[112:127]
    ds_read_b128 a[148:151], v22 offset:32768
    s_waitcnt lgkmcnt(6)
    v_mfma_f32_32x32x16_bf16 v[64:79], a[16:19], v[164:167], v[64:79]
    ds_read_b128 a[24:27], v19 offset:32768
    ds_read_b128 v[160:163], v27 offset:32768
    s_add_u32 s92, s64, 4
    s_and_b32 s92, s92, 7
    s_mul_i32 s93, s92, 229376
    s_lshl_b32 s92, s92, 7
    s_add_u32 m0, s58, 0
    s_add_u32 s98, s53, s92
    buffer_load_dwordx4 v2, s[4:7], s98 offen lds
    v_mfma_f32_32x32x16_bf16 v[80:95], a[16:19], v[176:179], v[80:95]
    ds_read_b128 v[172:175], v27 offset:33792
    ds_read_b64_tr_b16 v[192:193], v29 offset:40960
    v_mfma_f32_32x32x16_bf16 v[96:111], v[196:199], a[16:19], v[96:111]
    ds_read_b64_tr_b16 v[194:195], v29 offset:41216
    buffer_load_dwordx4 v3, s[4:7], s98 offen offset:1024 lds
    v_mfma_f32_32x32x16_bf16 v[112:127], v[196:199], a[144:147], v[112:127]
    ds_read_b128 a[152:155], v23 offset:32768
    s_waitcnt lgkmcnt(6)
    v_mfma_f32_32x32x16_bf16 v[64:79], a[20:23], v[168:171], v[64:79]
    ds_read_b128 a[28:31], v20 offset:32768
    ds_read_b128 v[164:167], v28 offset:32768
    buffer_load_dwordx4 v4, s[4:7], s98 offen offset:2048 lds
    v_mfma_f32_32x32x16_bf16 v[80:95], a[20:23], v[180:183], v[80:95]
    ds_read_b128 v[176:179], v28 offset:33792
    ds_read_b64_tr_b16 v[196:197], v29 offset:45056
    v_mfma_f32_32x32x16_bf16 v[96:111], v[200:203], a[20:23], v[96:111]
    ds_read_b64_tr_b16 v[198:199], v29 offset:45312
    buffer_load_dwordx4 v5, s[4:7], s98 offen offset:3072 lds
    v_mfma_f32_32x32x16_bf16 v[112:127], v[200:203], a[148:151], v[112:127]
    ds_read_b128 a[156:159], v24 offset:32768
    s_waitcnt lgkmcnt(6)
    v_mfma_f32_32x32x16_bf16 v[64:79], a[24:27], v[160:163], v[64:79]
    s_add_u32 m0, s59, 0
    s_add_u32 s98, s54, s92
    buffer_load_dwordx4 v6, s[8:11], s98 offen lds
    v_mfma_f32_32x32x16_bf16 v[80:95], a[24:27], v[172:175], v[80:95]
    s_waitcnt lgkmcnt(0)
    s_waitcnt vmcnt(22)
    s_barrier
    v_xor_b32 v17, 0x10000, v17
    v_xor_b32 v21, 0x10000, v21
    v_xor_b32 v25, 0x10000, v25
    v_xor_b32 v29, 0x10000, v29
    ds_read_b128 a[32:35], v17 offset:0
    ds_read_b128 v[168:171], v25 offset:0
    v_mfma_f32_32x32x16_bf16 v[96:111], v[192:195], a[24:27], v[96:111]
    ds_read_b128 v[180:183], v25 offset:1024
    ds_read_b64_tr_b16 v[200:201], v29 offset:0
    buffer_load_dwordx4 v6, s[12:15], s98 offen offset:1024 lds
    v_mfma_f32_32x32x16_bf16 v[112:127], v[192:195], a[152:155], v[112:127]
    ds_read_b64_tr_b16 v[202:203], v29 offset:256
    ds_read_b128 a[160:163], v21 offset:0
    v_mfma_f32_32x32x16_bf16 v[64:79], a[28:31], v[164:167], v[64:79]
    v_xor_b32 v18, 0x10000, v18
    v_xor_b32 v22, 0x10000, v22
    v_xor_b32 v26, 0x10000, v26
    ds_read_b128 a[36:39], v18 offset:0
    ds_read_b128 v[160:163], v26 offset:0
    s_add_u32 s98, s55, s93
    buffer_load_dwordx4 v7, s[16:19], s98 offen offset:2048 lds
    v_mfma_f32_32x32x16_bf16 v[80:95], a[28:31], v[176:179], v[80:95]
    ds_read_b128 v[172:175], v26 offset:1024
    ds_read_b64_tr_b16 v[192:193], v29 offset:4096
    v_mfma_f32_32x32x16_bf16 v[96:111], v[196:199], a[28:31], v[96:111]
    ds_read_b64_tr_b16 v[194:195], v29 offset:4352
    buffer_load_dwordx4 v8, s[20:23], s98 offen offset:3072 lds
    v_mfma_f32_32x32x16_bf16 v[112:127], v[196:199], a[156:159], v[112:127]
    ds_read_b128 a[164:167], v22 offset:0
    s_waitcnt lgkmcnt(6)
    v_mfma_f32_32x32x16_bf16 v[64:79], a[32:35], v[168:171], v[64:79]
    v_xor_b32 v19, 0x10000, v19
    v_xor_b32 v23, 0x10000, v23
    v_xor_b32 v27, 0x10000, v27
    ds_read_b128 a[40:43], v19 offset:0
    ds_read_b128 v[164:167], v27 offset:0
    s_add_u32 s92, s64, 5
    s_and_b32 s92, s92, 7
    s_mul_i32 s93, s92, 229376
    s_lshl_b32 s92, s92, 7
    s_add_u32 m0, s58, 32768
    s_add_u32 s98, s53, s92
    buffer_load_dwordx4 v2, s[4:7], s98 offen lds
    v_mfma_f32_32x32x16_bf16 v[80:95], a[32:35], v[180:183], v[80:95]
    ds_read_b128 v[176:179], v27 offset:1024
    ds_read_b64_tr_b16 v[196:197], v29 offset:8192
    v_mfma_f32_32x32x16_bf16 v[96:111], v[200:203], a[32:35], v[96:111]
    ds_read_b64_tr_b16 v[198:199], v29 offset:8448
    buffer_load_dwordx4 v3, s[4:7], s98 offen offset:1024 lds
    v_mfma_f32_32x32x16_bf16 v[112:127], v[200:203], a[160:163], v[112:127]
    ds_read_b128 a[168:171], v23 offset:0
    s_waitcnt lgkmcnt(6)
    v_mfma_f32_32x32x16_bf16 v[64:79], a[36:39], v[160:163], v[64:79]
    v_xor_b32 v20, 0x10000, v20
    v_xor_b32 v24, 0x10000, v24
    v_xor_b32 v28, 0x10000, v28
    ds_read_b128 a[44:47], v20 offset:0
    ds_read_b128 v[168:171], v28 offset:0
    buffer_load_dwordx4 v4, s[4:7], s98 offen offset:2048 lds
    v_mfma_f32_32x32x16_bf16 v[80:95], a[36:39], v[172:175], v[80:95]
    ds_read_b128 v[180:183], v28 offset:1024
    ds_read_b64_tr_b16 v[200:201], v29 offset:12288
    v_mfma_f32_32x32x16_bf16 v[96:111], v[192:195], a[36:39], v[96:111]
    ds_read_b64_tr_b16 v[202:203], v29 offset:12544
    buffer_load_dwordx4 v5, s[4:7], s98 offen offset:3072 lds
    v_mfma_f32_32x32x16_bf16 v[112:127], v[192:195], a[164:167], v[112:127]
    ds_read_b128 a[172:175], v24 offset:0
    s_waitcnt lgkmcnt(6)
    v_mfma_f32_32x32x16_bf16 v[64:79], a[40:43], v[164:167], v[64:79]
    s_add_u32 m0, s59, 32768
    s_add_u32 s98, s54, s92
    buffer_load_dwordx4 v6, s[8:11], s98 offen lds
    v_mov_b32 v54, 0
    buffer_load_dword v55, v54, s[28:31], 0 offen sc1
    v_mfma_f32_32x32x16_bf16 v[80:95], a[40:43], v[176:179], v[80:95]
    s_waitcnt lgkmcnt(0)
    s_waitcnt vmcnt(14)
    s_barrier
    ds_read_b128 a[48:51], v17 offset:32768
    ds_read_b128 v[160:163], v25 offset:32768
    v_mfma_f32_32x32x16_bf16 v[96:111], v[196:199], a[40:43], v[96:111]
    ds_read_b128 v[172:175], v25 offset:33792
    ds_read_b64_tr_b16 v[192:193], v29 offset:32768
    buffer_load_dwordx4 v6, s[12:15], s98 offen offset:1024 lds
    v_mfma_f32_32x32x16_bf16 v[112:127], v[196:199], a[168:171], v[112:127]
    ds_read_b64_tr_b16 v[194:195], v29 offset:33024
    ds_read_b128 a[176:179], v21 offset:32768
    v_mfma_f32_32x32x16_bf16 v[64:79], a[44:47], v[168:171], v[64:79]
    ds_read_b128 a[52:55], v18 offset:32768
    ds_read_b128 v[164:167], v26 offset:32768
    s_add_u32 s98, s55, s93
    buffer_load_dwordx4 v7, s[16:19], s98 offen offset:2048 lds
    v_lshlrev_b32 v128, 16, v128
    v_lshlrev_b32 v129, 16, v129
    v_mfma_f32_32x32x16_bf16 v[80:95], a[44:47], v[180:183], v[80:95]
    ds_read_b128 v[176:179], v26 offset:33792
    ds_read_b64_tr_b16 v[196:197], v29 offset:36864
    v_lshlrev_b32 v130, 16, v130
    v_mul_f32 v144, 0x3fb8aa3b, v130
    v_exp_f32 v144, v144
    v_mfma_f32_32x32x16_bf16 v[96:111], v[200:203], a[44:47], v[96:111]
    ds_read_b64_tr_b16 v[198:199], v29 offset:37120
    buffer_load_dwordx4 v8, s[20:23], s98 offen offset:3072 lds
    v_mul_f32 v149, v128, v128
    v_cvt_pk_bf16_f32 v144, v144, v144
    v_lshlrev_b32 v144, 16, v144
    v_mul_f32 v145, v144, v128
    v_mfma_f32_32x32x16_bf16 v[112:127], v[200:203], a[172:175], v[112:127]
    ds_read_b128 a[180:183], v22 offset:32768
    v_mul_f32 v146, v144, v129
    v_mul_f32 v145, 0x3fb8aa3b, v145
    v_mul_f32 v146, 0x3e22f983, v146
    v_exp_f32 v145, v145
    s_waitcnt lgkmcnt(6)
    v_mfma_f32_32x32x16_bf16 v[64:79], a[48:51], v[160:163], v[64:79]
    ds_read_b128 a[56:59], v19 offset:32768
    ds_read_b128 v[168:171], v27 offset:32768
    s_add_u32 s92, s64, 6
    s_and_b32 s92, s92, 7
    s_mul_i32 s93, s92, 229376
    s_lshl_b32 s92, s92, 7
    s_add_u32 m0, s58, 65536
    s_add_u32 s98, s53, s92
    buffer_load_dwordx4 v2, s[4:7], s98 offen lds
    v_mfma_f32_32x32x16_bf16 v[80:95], a[48:51], v[172:175], v[80:95]
    ds_read_b128 v[180:183], v27 offset:33792
    ds_read_b64_tr_b16 v[200:201], v29 offset:40960
    v_fract_f32 v146, v146
    v_fma_f32 v149, v129, v129, v149
    v_cos_f32 v147, v146
    v_mfma_f32_32x32x16_bf16 v[96:111], v[192:195], a[48:51], v[96:111]
    ds_read_b64_tr_b16 v[202:203], v29 offset:41216
    buffer_load_dwordx4 v3, s[4:7], s98 offen offset:1024 lds
    v_sin_f32 v148, v146
    v_rcp_f32 v149, v149
    v_mfma_f32_32x32x16_bf16 v[112:127], v[192:195], a[176:179], v[112:127]
    ds_read_b128 a[184:187], v23 offset:32768
    v_mul_f32 v33, v145, v147
    v_mul_f32 v34, v145, v148
    v_add_f32 v144, -1.0, v33
    v_add_f32 v149, v149, v149
    s_waitcnt lgkmcnt(6)
    v_mfma_f32_32x32x16_bf16 v[64:79], a[52:55], v[164:167], v[64:79]
    ds_read_b128 a[60:63], v20 offset:32768
    ds_read_b128 v[160:163], v28 offset:32768
    buffer_load_dwordx4 v4, s[4:7], s98 offen offset:2048 lds
    v_mul_f32 v146, v144, v128
    v_fma_f32 v146, v34, v129, v146
    v_mul_f32 v147, v34, v128
    v_mfma_f32_32x32x16_bf16 v[80:95], a[52:55], v[176:179], v[80:95]
    ds_read_b128 v[172:175], v28 offset:33792
    ds_read_b64_tr_b16 v[192:193], v29 offset:45056
    v_fma_f32 v147, -v144, v129, v147
    v_mul_f32 v35, v146, v149
    v_mul_f32 v36, v147, v149
    v_mul_f32 v150, v34, v34
    v_mfma_f32_32x32x16_bf16 v[96:111], v[196:199], a[52:55], v[96:111]
    ds_read_b64_tr_b16 v[194:195], v29 offset:45312
    buffer_load_dwordx4 v5, s[4:7], s98 offen offset:3072 lds
    v_mul_f32 v151, v33, v34
    v_fma_f32 v37, v33, v33, -v150
    v_add_f32 v38, v151, v151
    v_mul_f32 v150, v38, v38
    v_mfma_f32_32x32x16_bf16 v[112:127], v[196:199], a[180:183], v[112:127]
    ds_read_b128 a[188:191], v24 offset:32768
    v_mul_f32 v151, v37, v38
    v_fma_f32 v37, v37, v37, -v150
    v_add_f32 v38, v151, v151
    v_mul_f32 v150, v38, v38
    s_waitcnt lgkmcnt(6)
    v_mfma_f32_32x32x16_bf16 v[64:79], a[56:59], v[168:171], v[64:79]
    s_add_u32 m0, s59, 65536
    s_add_u32 s98, s54, s92
    buffer_load_dwordx4 v6, s[8:11], s98 offen lds
    v_mul_f32 v151, v37, v38
    v_fma_f32 v37, v37, v37, -v150
    v_add_f32 v38, v151, v151
    v_mfma_f32_32x32x16_bf16 v[80:95], a[56:59], v[180:183], v[80:95]
    s_waitcnt lgkmcnt(0)
    s_waitcnt vmcnt(14)
    s_barrier
    v_xor_b32 v17, 0x10000, v17
    v_xor_b32 v21, 0x10000, v21
    v_xor_b32 v25, 0x10000, v25
    v_xor_b32 v29, 0x10000, v29
    ds_read_b128 a[64:67], v17 offset:0
    ds_read_b128 v[164:167], v25 offset:0
    v_mfma_f32_32x32x16_bf16 v[96:111], v[200:203], a[56:59], v[96:111]
    ds_read_b128 v[176:179], v25 offset:1024
    ds_read_b64_tr_b16 v[196:197], v29 offset:0
    buffer_load_dwordx4 v6, s[12:15], s98 offen offset:1024 lds
    v_mul_f32 v150, v38, v38
    v_mul_f32 v151, v37, v38
    v_fma_f32 v37, v37, v37, -v150
    v_mfma_f32_32x32x16_bf16 v[112:127], v[200:203], a[184:187], v[112:127]
    ds_read_b64_tr_b16 v[198:199], v29 offset:256
    ds_read_b128 a[192:195], v21 offset:0
    v_add_f32 v38, v151, v151
    v_mul_f32 v150, v38, v38
    v_mul_f32 v151, v37, v38
    v_mfma_f32_32x32x16_bf16 v[64:79], a[60:63], v[160:163], v[64:79]
    v_xor_b32 v18, 0x10000, v18
    v_xor_b32 v22, 0x10000, v22
    v_xor_b32 v26, 0x10000, v26
    ds_read_b128 a[68:71], v18 offset:0
    ds_read_b128 v[168:171], v26 offset:0
    s_add_u32 s98, s55, s93
    buffer_load_dwordx4 v7, s[16:19], s98 offen offset:2048 lds
    v_mfma_f32_32x32x16_bf16 v[80:95], a[60:63], v[172:175], v[80:95]
    ds_read_b128 v[180:183], v26 offset:1024
    ds_read_b64_tr_b16 v[200:201], v29 offset:4096
    v_fma_f32 v39, v37, v37, -v150
    v_add_f32 v40, v151, v151
    v_mov_b32 v41, 1.0
    v_mov_b32 v42, 0
    v_mfma_f32_32x32x16_bf16 v[96:111], v[192:195], a[60:63], v[96:111]
    ds_read_b64_tr_b16 v[202:203], v29 offset:4352
    buffer_load_dwordx4 v8, s[20:23], s98 offen offset:3072 lds
    v_cndmask_b32 v41, v41, v37, s[66:67]
    v_cndmask_b32 v42, v42, v38, s[66:67]
    v_mul_f32 v150, v38, v38
    v_mul_f32 v153, v38, v37
    v_mfma_f32_32x32x16_bf16 v[112:127], v[192:195], a[188:191], v[112:127]
    ds_read_b128 a[196:199], v22 offset:0
    v_fma_f32 v152, v37, v37, -v150
    v_fma_f32 v153, v37, v38, v153
    v_cndmask_b32 v41, v41, v152, s[68:69]
    v_cndmask_b32 v42, v42, v153, s[68:69]
    s_waitcnt lgkmcnt(6)
    v_mfma_f32_32x32x16_bf16 v[64:79], a[64:67], v[164:167], v[64:79]
    v_xor_b32 v19, 0x10000, v19
    v_xor_b32 v23, 0x10000, v23
    v_xor_b32 v27, 0x10000, v27
    ds_read_b128 a[72:75], v19 offset:0
    ds_read_b128 v[160:163], v27 offset:0
    s_add_u32 s92, s64, 7
    s_and_b32 s92, s92, 7
    s_mul_i32 s93, s92, 229376
    s_lshl_b32 s92, s92, 7
    s_add_u32 m0, s58, 98304
    s_add_u32 s98, s53, s92
    buffer_load_dwordx4 v2, s[4:7], s98 offen lds
    v_mfma_f32_32x32x16_bf16 v[80:95], a[64:67], v[176:179], v[80:95]
    ds_read_b128 v[172:175], v27 offset:1024
    ds_read_b64_tr_b16 v[192:193], v29 offset:8192
    v_mul_f32 v150, v153, v38
    v_mul_f32 v155, v153, v37
    v_fma_f32 v154, v152, v37, -v150
    v_fma_f32 v155, v152, v38, v155
    v_mfma_f32_32x32x16_bf16 v[96:111], v[196:199], a[64:67], v[96:111]
    ds_read_b64_tr_b16 v[194:195], v29 offset:8448
    buffer_load_dwordx4 v3, s[4:7], s98 offen offset:1024 lds
    v_cndmask_b32 v41, v41, v154, s[70:71]
    v_cndmask_b32 v42, v42, v155, s[70:71]
    v_mul_f32 v150, v155, v38
    v_mul_f32 v153, v155, v37
    v_mfma_f32_32x32x16_bf16 v[112:127], v[196:199], a[192:195], v[112:127]
    ds_read_b128 a[200:203], v23 offset:0
    v_fma_f32 v152, v154, v37, -v150
    v_fma_f32 v153, v154, v38, v153
    v_cndmask_b32 v41, v41, v152, s[72:73]
    v_cndmask_b32 v42, v42, v153, s[72:73]
    s_waitcnt lgkmcnt(6)
    v_mfma_f32_32x32x16_bf16 v[64:79], a[68:71], v[168:171], v[64:79]
    v_xor_b32 v20, 0x10000, v20
    v_xor_b32 v24, 0x10000, v24
    v_xor_b32 v28, 0x10000, v28
    ds_read_b128 a[76:79], v20 offset:0
    ds_read_b128 v[164:167], v28 offset:0
    buffer_load_dwordx4 v4, s[4:7], s98 offen offset:2048 lds
    v_mfma_f32_32x32x16_bf16 v[80:95], a[68:71], v[180:183], v[80:95]
    ds_read_b128 v[176:179], v28 offset:1024
    ds_read_b64_tr_b16 v[196:197], v29 offset:12288
    v_mul_f32 v150, v153, v38
    v_mul_f32 v155, v153, v37
    v_fma_f32 v154, v152, v37, -v150
    v_fma_f32 v155, v152, v38, v155
    v_mfma_f32_32x32x16_bf16 v[96:111], v[200:203], a[68:71], v[96:111]
    ds_read_b64_tr_b16 v[198:199], v29 offset:12544
    buffer_load_dwordx4 v5, s[4:7], s98 offen offset:3072 lds
    v_cndmask_b32 v41, v41, v154, s[74:75]
    v_cndmask_b32 v42, v42, v155, s[74:75]
    v_mul_f32 v150, v155, v38
    v_mul_f32 v153, v155, v37
    v_mfma_f32_32x32x16_bf16 v[112:127], v[200:203], a[196:199], v[112:127]
    ds_read_b128 a[204:207], v24 offset:0
    v_fma_f32 v152, v154, v37, -v150
    v_fma_f32 v153, v154, v38, v153
    v_cndmask_b32 v41, v41, v152, s[76:77]
    v_cndmask_b32 v42, v42, v153, s[76:77]
    s_waitcnt lgkmcnt(6)
    v_mfma_f32_32x32x16_bf16 v[64:79], a[72:75], v[160:163], v[64:79]
    s_add_u32 m0, s59, 98304
    s_add_u32 s98, s54, s92
    buffer_load_dwordx4 v6, s[8:11], s98 offen lds
    v_mul_f32 v150, v153, v38
    v_mul_f32 v155, v153, v37
    v_fma_f32 v154, v152, v37, -v150
    v_mfma_f32_32x32x16_bf16 v[80:95], a[72:75], v[172:175], v[80:95]
    s_waitcnt lgkmcnt(0)
    s_waitcnt vmcnt(13)
    s_barrier
    ds_read_b128 a[80:83], v17 offset:32768
    ds_read_b128 v[168:171], v25 offset:32768
    v_fma_f32 v155, v152, v38, v155
    v_mfma_f32_32x32x16_bf16 v[96:111], v[192:195], a[72:75], v[96:111]
    ds_read_b128 v[180:183], v25 offset:33792
    ds_read_b64_tr_b16 v[200:201], v29 offset:32768
    buffer_load_dwordx4 v6, s[12:15], s98 offen offset:1024 lds
    v_cndmask_b32 v41, v41, v154, s[78:79]
    v_cndmask_b32 v42, v42, v155, s[78:79]
    v_mul_f32 v150, v40, v40
    v_mfma_f32_32x32x16_bf16 v[112:127], v[192:195], a[200:203], v[112:127]
    ds_read_b64_tr_b16 v[202:203], v29 offset:33024
    ds_read_b128 a[208:211], v21 offset:32768
    v_mul_f32 v151, v39, v40
    v_fma_f32 v39, v39, v39, -v150
    v_add_f32 v40, v151, v151
    v_mfma_f32_32x32x16_bf16 v[64:79], a[76:79], v[164:167], v[64:79]
    ds_read_b128 a[84:87], v18 offset:32768
    ds_read_b128 v[160:163], v26 offset:32768
    s_add_u32 s98, s55, s93
    buffer_load_dwordx4 v7, s[16:19], s98 offen offset:2048 lds
    v_mul_f32 v150, v40, v40
    v_mul_f32 v151, v39, v40
    v_mfma_f32_32x32x16_bf16 v[80:95], a[76:79], v[176:179], v[80:95]
    ds_read_b128 v[172:175], v26 offset:33792
    ds_read_b64_tr_b16 v[192:193], v29 offset:36864
    v_fma_f32 v39, v39, v39, -v150
    v_add_f32 v40, v151, v151
    v_dot2_f32_bf16 v240, v132, v140, 0
    v_dot2_f32_bf16 v240, v133, v141, v240
    v_mfma_f32_32x32x16_bf16 v[96:111], v[196:199], a[76:79], v[96:111]
    ds_read_b64_tr_b16 v[194:195], v29 offset:37120
    buffer_load_dwordx4 v8, s[20:23], s98 offen offset:3072 lds
    v_dot2_f32_bf16 v240, v134, v142, v240
    v_dot2_f32_bf16 v240, v135, v143, v240
    v_dot2_f32_bf16 v241, v136, v140, 0
    v_dot2_f32_bf16 v241, v137, v141, v241
    v_mfma_f32_32x32x16_bf16 v[112:127], v[196:199], a[204:207], v[112:127]
    ds_read_b128 a[212:215], v22 offset:32768
    v_dot2_f32_bf16 v241, v138, v142, v241
    v_dot2_f32_bf16 v241, v139, v143, v241
    s_nop 1
    v_add_f32_dpp v240, v240, v240 row_shr:1 row_mask:0xf bank_mask:0xf
    v_add_f32_dpp v241, v241, v241 row_shr:1 row_mask:0xf bank_mask:0xf
    s_waitcnt lgkmcnt(6)
    v_mfma_f32_32x32x16_bf16 v[64:79], a[80:83], v[168:171], v[64:79]
    ds_read_b128 a[88:91], v19 offset:32768
    ds_read_b128 v[164:167], v27 offset:32768
    s_add_u32 m0, s58, 0
    s_add_u32 s98, s64, s52
    s_add_u32 s98, s98, 0
    s_and_b32 s98, s98, 7
    s_mul_i32 s98, s98, 229376
    s_add_u32 s98, s98, s56
    s_add_u32 s98, s98, 2048
    buffer_load_dwordx4 v9, s[16:19], s98 offen lds
    v_mfma_f32_32x32x16_bf16 v[80:95], a[80:83], v[180:183], v[80:95]
    ds_read_b128 v[176:179], v27 offset:33792
    ds_read_b64_tr_b16 v[196:197], v29 offset:40960
    s_nop 1
    v_add_f32_dpp v240, v240, v240 row_shr:2 row_mask:0xf bank_mask:0xf
    v_add_f32_dpp v241, v241, v241 row_shr:2 row_mask:0xf bank_mask:0xf
    s_nop 1
    v_add_f32_dpp v240, v240, v240 row_shr:4 row_mask:0xf bank_mask:0xf
    v_add_f32_dpp v241, v241, v241 row_shr:4 row_mask:0xf bank_mask:0xf
    v_mfma_f32_32x32x16_bf16 v[96:111], v[200:203], a[80:83], v[96:111]
    ds_read_b64_tr_b16 v[198:199], v29 offset:41216
    buffer_load_dwordx4 v10, s[16:19], s98 offen offset:1024 lds
    s_nop 1
    v_add_f32_dpp v240, v240, v240 row_shr:8 row_mask:0xf bank_mask:0xf
    v_add_f32_dpp v241, v241, v241 row_shr:8 row_mask:0xf bank_mask:0xf
    s_nop 1
    v_add_f32_dpp v240, v240, v240 row_bcast:15 row_mask:0xa bank_mask:0xf
    v_add_f32_dpp v241, v241, v241 row_bcast:15 row_mask:0xa bank_mask:0xf
    v_mfma_f32_32x32x16_bf16 v[112:127], v[200:203], a[208:211], v[112:127]
    ds_read_b128 a[216:219], v23 offset:32768
    s_nop 1
    v_add_f32_dpp v240, v240, v240 row_bcast:31 row_mask:0xc bank_mask:0xf
    v_add_f32_dpp v241, v241, v241 row_bcast:31 row_mask:0xc bank_mask:0xf
    v_cvt_pk_bf16_f32 v232, v240, v241
    s_waitcnt lgkmcnt(6)
    v_mfma_f32_32x32x16_bf16 v[64:79], a[84:87], v[160:163], v[64:79]
    ds_read_b128 a[92:95], v20 offset:32768
    ds_read_b128 v[168:171], v28 offset:32768
    buffer_load_dwordx4 v11, s[16:19], s98 offen offset:2048 lds
    v_lshlrev_b32 v240, 16, v232
    v_and_b32 v241, 0xffff0000, v232
    v_mul_f32 v240, 0xbfb8aa3b, v240
    v_mfma_f32_32x32x16_bf16 v[80:95], a[84:87], v[172:175], v[80:95]
    ds_read_b128 v[180:183], v28 offset:33792
    ds_read_b64_tr_b16 v[200:201], v29 offset:45056
    v_mul_f32 v241, 0xbfb8aa3b, v241
    v_exp_f32 v240, v240
    v_exp_f32 v241, v241
    v_mfma_f32_32x32x16_bf16 v[96:111], v[192:195], a[84:87], v[96:111]
    ds_read_b64_tr_b16 v[202:203], v29 offset:45312
    buffer_load_dwordx4 v12, s[16:19], s98 offen offset:3072 lds
    v_mov_b32 v236, s100
    v_add_f32 v240, 1.0, v240
    v_add_f32 v241, 1.0, v241
    v_rcp_f32 v240, v240
    v_mfma_f32_32x32x16_bf16 v[112:127], v[192:195], a[212:215], v[112:127]
    ds_read_b128 a[220:223], v24 offset:32768
    v_rcp_f32 v241, v241
    s_nop 0
    v_cvt_pk_bf16_f32 v232, v240, v241
    s_waitcnt lgkmcnt(6)
    v_mfma_f32_32x32x16_bf16 v[64:79], a[88:91], v[164:167], v[64:79]
    s_add_u32 m0, s59, 0
    s_add_u32 s98, s64, s52
    s_add_u32 s98, s98, 0
    s_and_b32 s98, s98, 7
    s_mul_i32 s98, s98, 229376
    s_add_u32 s98, s98, s56
    s_add_u32 s98, s98, 3072
    buffer_load_dwordx4 v13, s[20:23], s98 offen lds
    v_mfma_f32_32x32x16_bf16 v[80:95], a[88:91], v[176:179], v[80:95]
    s_waitcnt lgkmcnt(0)
    s_waitcnt vmcnt(13)
    s_barrier
    v_xor_b32 v17, 0x10000, v17
    v_xor_b32 v21, 0x10000, v21
    v_xor_b32 v25, 0x10000, v25
    v_xor_b32 v29, 0x10000, v29
    ds_read_b128 a[96:99], v17 offset:0
    ds_read_b128 v[160:163], v25 offset:0
    v_mfma_f32_32x32x16_bf16 v[96:111], v[196:199], a[88:91], v[96:111]
    ds_read_b128 v[172:175], v25 offset:1024
    ds_read_b64_tr_b16 v[192:193], v29 offset:0
    buffer_load_dwordx4 v14, s[20:23], s98 offen offset:1024 lds
    v_cmp_eq_u32 vcc, 63, v1
    v_lshlrev_b32 v234, 16, v232
    v_and_b32 v235, 0xffff0000, v232
    v_cndmask_b32 v236, v236, v52, vcc
    buffer_store_dwordx2 v[234:235], v236, s[24:27], 0 offen sc1
    v_mfma_f32_32x32x16_bf16 v[112:127], v[196:199], a[216:219], v[112:127]
    ds_read_b64_tr_b16 v[194:195], v29 offset:256
    ds_read_b128 a[224:227], v21 offset:0
    v_lshrrev_b32 v228, 2, v245
    v_lshl_add_u32 v228, v61, 2, v228
    v_lshlrev_b32 v228, 6, v228
    v_lshl_add_u32 v228, v244, 5, v228
    v_and_b32 v229, 3, v245
    v_lshl_add_u32 v228, v229, 3, v228
    s_add_u32 s62, s58, 131072
    v_add_u32 v228, s62, v228
    ds_read_b64_tr_b16 v[148:149], v228 offset:0
    ds_read_b64_tr_b16 v[150:151], v228 offset:512
    ds_read_b64_tr_b16 v[152:153], v228 offset:1024
    ds_read_b64_tr_b16 v[154:155], v228 offset:1536
    v_mfma_f32_32x32x16_bf16 v[64:79], a[92:95], v[168:171], v[64:79]
    v_xor_b32 v18, 0x10000, v18
    v_xor_b32 v22, 0x10000, v22
    v_xor_b32 v26, 0x10000, v26
    ds_read_b128 a[100:103], v18 offset:0
    ds_read_b128 v[164:167], v26 offset:0
    buffer_load_dwordx4 v15, s[20:23], s98 offen offset:2048 lds
    v_mfma_f32_32x32x16_bf16 v[80:95], a[92:95], v[180:183], v[80:95]
    ds_read_b128 v[176:179], v26 offset:1024
    ds_read_b64_tr_b16 v[196:197], v29 offset:4096
    v_lshrrev_b32 v228, 4, v62
    v_lshlrev_b32 v228, 12, v228
    v_and_b32 v229, 15, v62
    v_lshl_add_u32 v228, v229, 6, v228
    v_lshl_add_u32 v228, v61, 3, v228
    s_lshl_b32 s62, s50, 4
    s_add_u32 s62, s62, 133120
    v_add_u32 v228, s62, v228
    ds_read_b64 v[56:57], v228
    ds_read_b64 v[58:59], v228 offset:8192
    v_mfma_f32_32x32x16_bf16 v[96:111], v[200:203], a[92:95], v[96:111]
    ds_read_b64_tr_b16 v[198:199], v29 offset:4352
    buffer_load_dwordx4 v16, s[20:23], s98 offen offset:3072 lds
    s_waitcnt lgkmcnt(1)
    s_mov_b32 s60, 0x05040100
    s_mov_b32 s61, 0x07060302
    v_perm_b32 v156, v58, v56, s60
    v_perm_b32 v157, v58, v56, s61
    v_perm_b32 v158, v59, v57, s60
    v_perm_b32 v159, v59, v57, s61
    v_mfma_f32_32x32x16_bf16 v[112:127], v[200:203], a[220:223], v[112:127]
    ds_read_b128 a[228:231], v22 offset:0
    s_lshr_b32 s62, s48, 1
    s_mul_i32 s62, s62, 360448
    s_and_b32 s63, s48, 1
    s_lshl_b32 s63, s63, 10
    s_add_u32 s62, s62, s63
    s_add_u32 s62, s62, 12582912
    s_lshl_b32 s63, s49, 2
    s_add_u32 s63, s63, s50
    s_lshl_b32 s63, s63, 11
    s_add_u32 s63, s63, s62
    buffer_store_dwordx4 v[156:159], v60, s[24:27], s63 offen sc1
    s_mul_i32 s63, s49, 7
    s_add_u32 s63, s63, 64
    s_add_u32 s63, s63, s50
    s_lshl_b32 s63, s63, 11
    s_add_u32 s63, s63, s62
    buffer_store_dwordx4 v[148:151], v60, s[24:27], s63 offen sc1
    s_add_u32 s62, s50, 4
    s_min_u32 s62, s62, 6
    s_sub_u32 s62, s62, s50
    s_lshl_b32 s62, s62, 11
    s_add_u32 s63, s63, s62
    buffer_store_dwordx4 v[152:155], v60, s[24:27], s63 offen sc1
    v_mfma_f32_32x32x16_bf16 v[64:79], a[96:99], v[160:163], v[64:79]
    v_xor_b32 v19, 0x10000, v19
    v_xor_b32 v23, 0x10000, v23
    v_xor_b32 v27, 0x10000, v27
    ds_read_b128 a[104:107], v19 offset:0
    ds_read_b128 v[168:171], v27 offset:0
    s_add_u32 m0, s58, 32768
    s_add_u32 s98, s64, s52
    s_add_u32 s98, s98, 2
    s_and_b32 s98, s98, 7
    s_mul_i32 s98, s98, 229376
    s_add_u32 s98, s98, s56
    s_add_u32 s98, s98, 2048
    buffer_load_dwordx4 v9, s[16:19], s98 offen lds
    v_mfma_f32_32x32x16_bf16 v[80:95], a[96:99], v[172:175], v[80:95]
    ds_read_b128 v[180:183], v27 offset:1024
    ds_read_b64_tr_b16 v[200:201], v29 offset:8192
    v_mfma_f32_32x32x16_bf16 v[96:111], v[192:195], a[96:99], v[96:111]
    ds_read_b64_tr_b16 v[202:203], v29 offset:8448
    buffer_load_dwordx4 v10, s[16:19], s98 offen offset:1024 lds
    v_mfma_f32_32x32x16_bf16 v[112:127], v[192:195], a[224:227], v[112:127]
    ds_read_b128 a[232:235], v23 offset:0
    s_waitcnt lgkmcnt(6)
    v_mfma_f32_32x32x16_bf16 v[64:79], a[100:103], v[164:167], v[64:79]
    v_xor_b32 v20, 0x10000, v20
    v_xor_b32 v24, 0x10000, v24
    v_xor_b32 v28, 0x10000, v28
    ds_read_b128 a[108:111], v20 offset:0
    ds_read_b128 v[160:163], v28 offset:0
    buffer_load_dwordx4 v11, s[16:19], s98 offen offset:2048 lds
    v_mfma_f32_32x32x16_bf16 v[80:95], a[100:103], v[176:179], v[80:95]
    ds_read_b128 v[172:175], v28 offset:1024
    ds_read_b64_tr_b16 v[192:193], v29 offset:12288
    v_mfma_f32_32x32x16_bf16 v[96:111], v[196:199], a[100:103], v[96:111]
    ds_read_b64_tr_b16 v[194:195], v29 offset:12544
    buffer_load_dwordx4 v12, s[16:19], s98 offen offset:3072 lds
    v_mfma_f32_32x32x16_bf16 v[112:127], v[196:199], a[228:231], v[112:127]
    ds_read_b128 a[236:239], v24 offset:0
    s_waitcnt lgkmcnt(6)
    v_mfma_f32_32x32x16_bf16 v[64:79], a[104:107], v[168:171], v[64:79]
    s_add_u32 m0, s59, 32768
    s_add_u32 s98, s64, s52
    s_add_u32 s98, s98, 2
    s_and_b32 s98, s98, 7
    s_mul_i32 s98, s98, 229376
    s_add_u32 s98, s98, s56
    s_add_u32 s98, s98, 3072
    buffer_load_dwordx4 v13, s[20:23], s98 offen lds
    v_mfma_f32_32x32x16_bf16 v[80:95], a[104:107], v[180:183], v[80:95]
    s_waitcnt lgkmcnt(0)
    s_waitcnt vmcnt(17)
    s_barrier
    ds_read_b128 a[112:115], v17 offset:32768
    ds_read_b128 v[164:167], v25 offset:32768
    v_mfma_f32_32x32x16_bf16 v[96:111], v[200:203], a[104:107], v[96:111]
    ds_read_b128 v[176:179], v25 offset:33792
    ds_read_b64_tr_b16 v[196:197], v29 offset:32768
    buffer_load_dwordx4 v14, s[20:23], s98 offen offset:1024 lds
    v_mfma_f32_32x32x16_bf16 v[112:127], v[200:203], a[232:235], v[112:127]
    ds_read_b64_tr_b16 v[198:199], v29 offset:33024
    ds_read_b128 a[240:243], v21 offset:32768
    v_mfma_f32_32x32x16_bf16 v[64:79], a[108:111], v[160:163], v[64:79]
    ds_read_b128 a[116:119], v18 offset:32768
    ds_read_b128 v[168:171], v26 offset:32768
    buffer_load_dwordx4 v15, s[20:23], s98 offen offset:2048 lds
    v_mfma_f32_32x32x16_bf16 v[80:95], a[108:111], v[172:175], v[80:95]
    ds_read_b128 v[180:183], v26 offset:33792
    ds_read_b64_tr_b16 v[200:201], v29 offset:36864
    v_mfma_f32_32x32x16_bf16 v[96:111], v[192:195], a[108:111], v[96:111]
    ds_read_b64_tr_b16 v[202:203], v29 offset:37120
    buffer_load_dwordx4 v16, s[20:23], s98 offen offset:3072 lds
    v_mfma_f32_32x32x16_bf16 v[112:127], v[192:195], a[236:239], v[112:127]
    ds_read_b128 a[244:247], v22 offset:32768
    s_waitcnt lgkmcnt(6)
    v_mfma_f32_32x32x16_bf16 v[64:79], a[112:115], v[164:167], v[64:79]
    ds_read_b128 a[120:123], v19 offset:32768
    ds_read_b128 v[160:163], v27 offset:32768
    s_add_u32 m0, s58, 65536
    s_add_u32 s98, s64, s52
    s_add_u32 s98, s98, 4
    s_and_b32 s98, s98, 7
    s_mul_i32 s98, s98, 229376
    s_add_u32 s98, s98, s56
    s_add_u32 s98, s98, 2048
    buffer_load_dwordx4 v9, s[16:19], s98 offen lds
    v_mfma_f32_32x32x16_bf16 v[80:95], a[112:115], v[176:179], v[80:95]
    ds_read_b128 v[172:175], v27 offset:33792
    ds_read_b64_tr_b16 v[192:193], v29 offset:40960
gated_mix__ssm_conv_s5__glu_gated_geglu__prompt_kernel_chk_n:
    v_cmp_ne_u32 vcc, 0, v55
    s_and_b32 s60, vcc_lo, -1
    s_cmp_eq_u32 s60, -1
    s_cbranch_scc0 gated_mix__ssm_conv_s5__glu_gated_geglu__prompt_kernel_spin_n
gated_mix__ssm_conv_s5__glu_gated_geglu__prompt_kernel_ok_n:
    v_readfirstlane_b32 s101, v55
    s_nop 3
    v_mfma_f32_32x32x16_bf16 v[96:111], v[196:199], a[112:115], v[96:111]
    ds_read_b64_tr_b16 v[194:195], v29 offset:41216
    buffer_load_dwordx4 v10, s[16:19], s98 offen offset:1024 lds
    v_mfma_f32_32x32x16_bf16 v[112:127], v[196:199], a[240:243], v[112:127]
    ds_read_b128 a[248:251], v23 offset:32768
    s_waitcnt lgkmcnt(6)
    v_mfma_f32_32x32x16_bf16 v[64:79], a[116:119], v[168:171], v[64:79]
    ds_read_b128 a[124:127], v20 offset:32768
    ds_read_b128 v[164:167], v28 offset:32768
    buffer_load_dwordx4 v11, s[16:19], s98 offen offset:2048 lds
    v_mfma_f32_32x32x16_bf16 v[80:95], a[116:119], v[180:183], v[80:95]
    ds_read_b128 v[176:179], v28 offset:33792
    ds_read_b64_tr_b16 v[196:197], v29 offset:45056
    v_mfma_f32_32x32x16_bf16 v[96:111], v[200:203], a[116:119], v[96:111]
    ds_read_b64_tr_b16 v[198:199], v29 offset:45312
    buffer_load_dwordx4 v12, s[16:19], s98 offen offset:3072 lds
    v_mfma_f32_32x32x16_bf16 v[112:127], v[200:203], a[244:247], v[112:127]
    ds_read_b128 a[252:255], v24 offset:32768
    s_waitcnt lgkmcnt(6)
    v_mfma_f32_32x32x16_bf16 v[64:79], a[120:123], v[160:163], v[64:79]
    s_add_u32 m0, s59, 65536
    s_add_u32 s98, s64, s52
    s_add_u32 s98, s98, 4
    s_and_b32 s98, s98, 7
    s_mul_i32 s98, s98, 229376
    s_add_u32 s98, s98, s56
    s_add_u32 s98, s98, 3072
    buffer_load_dwordx4 v13, s[20:23], s98 offen lds
    v_mfma_f32_32x32x16_bf16 v[80:95], a[120:123], v[172:175], v[80:95]
    s_waitcnt lgkmcnt(0)
    s_waitcnt vmcnt(16)
    s_barrier
    ds_read_b64_tr_b16 v[200:201], v30 offset:0
    v_mfma_f32_32x32x16_bf16 v[96:111], v[192:195], a[120:123], v[96:111]
    ds_read_b64_tr_b16 v[202:203], v30 offset:512
    buffer_load_dwordx4 v14, s[20:23], s98 offen offset:1024 lds
    v_mfma_f32_32x32x16_bf16 v[112:127], v[192:195], a[248:251], v[112:127]
    v_mfma_f32_32x32x16_bf16 v[64:79], a[124:127], v[164:167], v[64:79]
    ds_read_b64_tr_b16 v[204:205], v30 offset:2048
    buffer_load_dwordx4 v15, s[20:23], s98 offen offset:2048 lds
    v_mfma_f32_32x32x16_bf16 v[80:95], a[124:127], v[176:179], v[80:95]
    ds_read_b64_tr_b16 v[206:207], v30 offset:2560
    v_mfma_f32_32x32x16_bf16 v[96:111], v[196:199], a[124:127], v[96:111]
    buffer_load_dwordx4 v16, s[20:23], s98 offen offset:3072 lds
    v_mfma_f32_32x32x16_bf16 v[112:127], v[196:199], a[252:255], v[112:127]
    s_waitcnt lgkmcnt(2)
    v_mfma_f32_32x32x16_bf16 v[128:143], v[200:203], a[0:3], 0
    ds_read_b64_tr_b16 v[192:193], v30 offset:4096
    ds_read_b64_tr_b16 v[194:195], v30 offset:4608
    s_add_u32 m0, s58, 98304
    s_add_u32 s98, s64, s52
    s_add_u32 s98, s98, 6
    s_and_b32 s98, s98, 7
    s_mul_i32 s98, s98, 229376
    s_add_u32 s98, s98, s56
    s_add_u32 s98, s98, 2048
    buffer_load_dwordx4 v9, s[16:19], s98 offen lds
    v_mfma_f32_32x32x16_bf16 v[144:159], v[200:203], a[128:131], 0
    ds_read_b64_tr_b16 v[196:197], v30 offset:6144
    ds_read_b64_tr_b16 v[198:199], v30 offset:6656
    s_waitcnt lgkmcnt(4)
    v_mfma_f32_32x32x16_bf16 v[128:143], v[204:207], a[4:7], v[128:143]
    ds_read_b64_tr_b16 v[200:201], v30 offset:8192
    buffer_load_dwordx4 v10, s[16:19], s98 offen offset:1024 lds
    v_mfma_f32_32x32x16_bf16 v[144:159], v[204:207], a[132:135], v[144:159]
    ds_read_b64_tr_b16 v[202:203], v30 offset:8704
    s_waitcnt lgkmcnt(4)
    v_mfma_f32_32x32x16_bf16 v[128:143], v[192:195], a[8:11], v[128:143]
    ds_read_b64_tr_b16 v[204:205], v30 offset:10240
    buffer_load_dwordx4 v11, s[16:19], s98 offen offset:2048 lds
    v_fma_f32 v232, v33, v64, v65
    v_fma_f32 v233, v33, v80, v81
    v_fma_f32 v232, -v34, v80, v232
    v_fma_f32 v233, v34, v64, v233
    v_mfma_f32_32x32x16_bf16 v[144:159], v[192:195], a[136:139], v[144:159]
    ds_read_b64_tr_b16 v[206:207], v30 offset:10752
    v_fma_f32 v234, v33, v232, v66
    v_fma_f32 v235, v33, v233, v82
    v_fma_f32 v234, -v34, v233, v234
    v_fma_f32 v235, v34, v232, v235
    s_waitcnt lgkmcnt(4)
    v_mfma_f32_32x32x16_bf16 v[128:143], v[196:199], a[12:15], v[128:143]
    ds_read_b64_tr_b16 v[192:193], v30 offset:12288
    buffer_load_dwordx4 v12, s[16:19], s98 offen offset:3072 lds
    v_fma_f32 v232, v33, v234, v67
    v_fma_f32 v233, v33, v235, v83
    v_fma_f32 v232, -v34, v235, v232
    v_fma_f32 v233, v34, v234, v233
    v_mfma_f32_32x32x16_bf16 v[144:159], v[196:199], a[140:143], v[144:159]
    ds_read_b64_tr_b16 v[194:195], v30 offset:12800
    v_fma_f32 v234, v33, v232, v68
    v_fma_f32 v235, v33, v233, v84
    v_fma_f32 v234, -v34, v233, v234
    v_fma_f32 v235, v34, v232, v235
    s_waitcnt lgkmcnt(4)
    v_mfma_f32_32x32x16_bf16 v[128:143], v[200:203], a[16:19], v[128:143]
    ds_read_b64_tr_b16 v[196:197], v30 offset:14336
    s_add_u32 m0, s59, 98304
    s_add_u32 s98, s64, s52
    s_add_u32 s98, s98, 6
    s_and_b32 s98, s98, 7
    s_mul_i32 s98, s98, 229376
    s_add_u32 s98, s98, s56
    s_add_u32 s98, s98, 3072
    buffer_load_dwordx4 v13, s[20:23], s98 offen lds
    v_mfma_f32_32x32x16_bf16 v[144:159], v[200:203], a[144:147], v[144:159]
    ds_read_b64_tr_b16 v[198:199], v30 offset:14848
    v_fma_f32 v232, v33, v234, v69
    v_fma_f32 v233, v33, v235, v85
    v_fma_f32 v232, -v34, v235, v232
    v_fma_f32 v233, v34, v234, v233
    s_waitcnt lgkmcnt(4)
    v_mfma_f32_32x32x16_bf16 v[128:143], v[204:207], a[20:23], v[128:143]
    buffer_load_dwordx4 v14, s[20:23], s98 offen offset:1024 lds
    v_fma_f32 v234, v33, v232, v70
    v_fma_f32 v235, v33, v233, v86
    v_fma_f32 v234, -v34, v233, v234
    v_fma_f32 v235, v34, v232, v235
    v_fma_f32 v232, v33, v234, v71
    v_mfma_f32_32x32x16_bf16 v[144:159], v[204:207], a[148:151], v[144:159]
    s_waitcnt lgkmcnt(0)
    s_waitcnt vmcnt(14)
    s_barrier
    s_lshl_b32 s62, s49, 4
    s_add_u32 s62, s62, s48
    s_lshl_b32 s62, s62, 7
    s_add_u32 s62, s62, 15990784
    v_cmp_eq_u32 vcc, 0, v0
    v_mov_b32 v54, s100
    v_mov_b32 v55, s62
    v_cndmask_b32 v54, v54, v55, vcc
    v_mov_b32 v55, s101
    buffer_store_dword v55, v54, s[24:27], 0 offen sc1
    ds_read_b64_tr_b16 v[200:201], v30 offset:32768
    ds_read_b64_tr_b16 v[202:203], v30 offset:33280
    v_mfma_f32_32x32x16_bf16 v[128:143], v[192:195], a[24:27], v[128:143]
    ds_read_b64_tr_b16 v[204:205], v30 offset:34816
    buffer_load_dwordx4 v15, s[20:23], s98 offen offset:2048 lds
    v_fma_f32 v233, v33, v235, v87
    v_fma_f32 v232, -v34, v235, v232
    v_fma_f32 v233, v34, v234, v233
    v_fma_f32 v234, v33, v232, v72
    v_mfma_f32_32x32x16_bf16 v[144:159], v[192:195], a[152:155], v[144:159]
    ds_read_b64_tr_b16 v[206:207], v30 offset:35328
    v_fma_f32 v235, v33, v233, v88
    v_fma_f32 v234, -v34, v233, v234
    v_fma_f32 v235, v34, v232, v235
    v_fma_f32 v232, v33, v234, v73
    v_mfma_f32_32x32x16_bf16 v[128:143], v[196:199], a[28:31], v[128:143]
    ds_read_b64_tr_b16 v[192:193], v30 offset:36864
    buffer_load_dwordx4 v16, s[20:23], s98 offen offset:3072 lds
    v_fma_f32 v233, v33, v235, v89
    v_fma_f32 v232, -v34, v235, v232
    v_fma_f32 v233, v34, v234, v233
    v_fma_f32 v234, v33, v232, v74
    v_mfma_f32_32x32x16_bf16 v[144:159], v[196:199], a[156:159], v[144:159]
    ds_read_b64_tr_b16 v[194:195], v30 offset:37376
    v_fma_f32 v235, v33, v233, v90
    v_fma_f32 v234, -v34, v233, v234
    v_fma_f32 v235, v34, v232, v235
    v_fma_f32 v232, v33, v234, v75
    s_waitcnt lgkmcnt(4)
    v_mfma_f32_32x32x16_bf16 v[128:143], v[200:203], a[32:35], v[128:143]
    ds_read_b64_tr_b16 v[196:197], v30 offset:38912
    v_lshrrev_b32 v228, 1, v1
    v_and_b32 v229, 1, v1
    v_lshlrev_b32 v229, 4, v229
    v_mul_u32_u24 v9, 3584, v228
    v_xor_b32 v228, 4, v228
    v_mfma_f32_32x32x16_bf16 v[144:159], v[200:203], a[160:163], v[144:159]
    ds_read_b64_tr_b16 v[198:199], v30 offset:39424
    v_mul_u32_u24 v13, 3584, v228
    v_add_u32 v9, v9, v229
    v_add_u32 v13, v13, v229
    v_add_u32 v10, 114688, v9
    s_waitcnt lgkmcnt(4)
    v_mfma_f32_32x32x16_bf16 v[128:143], v[204:207], a[36:39], v[128:143]
    ds_read_b64_tr_b16 v[200:201], v30 offset:40960
    v_add_u32 v14, 114688, v13
    s_lshl_b32 s62, s50, 1
    s_add_u32 s62, s62, s64
    s_add_u32 s62, s62, 1
    s_and_b32 s62, s62, 7
    s_mul_i32 s62, s62, 229376
    s_add_u32 s53, s62, s57
    v_mfma_f32_32x32x16_bf16 v[144:159], v[204:207], a[164:167], v[144:159]
    ds_read_b64_tr_b16 v[202:203], v30 offset:41472
    s_lshl_b32 s62, s50, 1
    s_add_u32 s62, s62, s64
    s_and_b32 s62, s62, 7
    s_mul_i32 s62, s62, 229376
    s_add_u32 s57, s62, s57
    s_waitcnt lgkmcnt(4)
    v_mfma_f32_32x32x16_bf16 v[128:143], v[192:195], a[40:43], v[128:143]
    ds_read_b64_tr_b16 v[204:205], v30 offset:43008
    v_fma_f32 v233, v33, v235, v91
    v_fma_f32 v232, -v34, v235, v232
    v_fma_f32 v233, v34, v234, v233
    v_fma_f32 v234, v33, v232, v76
    v_fma_f32 v235, v33, v233, v92
    v_mfma_f32_32x32x16_bf16 v[144:159], v[192:195], a[168:171], v[144:159]
    ds_read_b64_tr_b16 v[206:207], v30 offset:43520
    v_fma_f32 v234, -v34, v233, v234
    v_fma_f32 v235, v34, v232, v235
    v_fma_f32 v232, v33, v234, v77
    v_fma_f32 v233, v33, v235, v93
    s_waitcnt lgkmcnt(4)
    v_mfma_f32_32x32x16_bf16 v[128:143], v[196:199], a[44:47], v[128:143]
    ds_read_b64_tr_b16 v[192:193], v30 offset:45056
    v_fma_f32 v232, -v34, v235, v232
    v_fma_f32 v233, v34, v234, v233
    v_fma_f32 v234, v33, v232, v78
    v_fma_f32 v235, v33, v233, v94
    v_fma_f32 v234, -v34, v233, v234
    v_mfma_f32_32x32x16_bf16 v[144:159], v[196:199], a[172:175], v[144:159]
    ds_read_b64_tr_b16 v[194:195], v30 offset:45568
    v_fma_f32 v235, v34, v232, v235
    v_fma_f32 v232, v33, v234, v79
    v_fma_f32 v233, v33, v235, v95
    v_fma_f32 v232, -v34, v235, v232
    s_waitcnt lgkmcnt(4)
    v_mfma_f32_32x32x16_bf16 v[128:143], v[200:203], a[48:51], v[128:143]
    ds_read_b64_tr_b16 v[196:197], v30 offset:47104
    s_add_u32 m0, s58, 131072
    s_add_u32 s98, s57, 2048
    buffer_load_dwordx4 v9, s[16:19], s98 offen lds
    v_fma_f32 v233, v34, v234, v233
    ds_write_b64 v45, v[232:233]
    v_mfma_f32_32x32x16_bf16 v[144:159], v[200:203], a[176:179], v[144:159]
    ds_read_b64_tr_b16 v[198:199], v30 offset:47616
    v_mul_f32 v216, v96, v96
    v_mul_f32 v217, v97, v97
    v_fmamk_f32 v216, v216, 0xbdd2d3e8, v48
    v_fmamk_f32 v217, v217, 0xbdd2d3e8, v48
    s_waitcnt lgkmcnt(5)
    v_mfma_f32_32x32x16_bf16 v[128:143], v[204:207], a[52:55], v[128:143]
    v_mul_f32 v216, v96, v216
    v_mul_f32 v217, v97, v217
    v_exp_f32 v216, v216
    v_exp_f32 v217, v217
    v_mfma_f32_32x32x16_bf16 v[144:159], v[204:207], a[180:183], v[144:159]
    s_waitcnt lgkmcnt(0)
    s_waitcnt vmcnt(10)
    s_barrier
    v_xor_b32 v30, 0x10000, v30
    ds_read_b64_tr_b16 v[200:201], v30 offset:0
    ds_read_b64_tr_b16 v[202:203], v30 offset:512
    v_mfma_f32_32x32x16_bf16 v[128:143], v[192:195], a[56:59], v[128:143]
    ds_read_b64_tr_b16 v[204:205], v30 offset:2048
    v_mul_f32 v218, v96, v104
    v_mul_f32 v219, v97, v105
    v_add_f32 v216, 1.0, v216
    v_add_f32 v217, 1.0, v217
    v_rcp_f32 v216, v216
    v_mfma_f32_32x32x16_bf16 v[144:159], v[192:195], a[184:187], v[144:159]
    ds_read_b64_tr_b16 v[206:207], v30 offset:2560
    v_rcp_f32 v217, v217
    v_mul_f32 v224, v98, v98
    v_mul_f32 v225, v99, v99
    v_mfma_f32_32x32x16_bf16 v[128:143], v[196:199], a[60:63], v[128:143]
    ds_read_b64_tr_b16 v[192:193], v30 offset:4096
    v_mul_f32 v218, v218, v216
    v_mul_f32 v219, v219, v217
    v_cvt_pk_bf16_f32 v208, v218, v219
    v_fmamk_f32 v224, v224, 0xbdd2d3e8, v48
    v_fmamk_f32 v225, v225, 0xbdd2d3e8, v48
    v_mfma_f32_32x32x16_bf16 v[144:159], v[196:199], a[188:191], v[144:159]
    ds_read_b64_tr_b16 v[194:195], v30 offset:4608
    v_mul_f32 v224, v98, v224
    v_mul_f32 v225, v99, v225
    v_exp_f32 v224, v224
    s_waitcnt lgkmcnt(4)
    v_mfma_f32_32x32x16_bf16 v[128:143], v[200:203], a[64:67], v[128:143]
    ds_read_b64_tr_b16 v[196:197], v30 offset:6144
    v_exp_f32 v225, v225
    v_mul_f32 v226, v98, v106
    v_mul_f32 v227, v99, v107
    v_add_f32 v224, 1.0, v224
    v_mfma_f32_32x32x16_bf16 v[144:159], v[200:203], a[192:195], v[144:159]
    ds_read_b64_tr_b16 v[198:199], v30 offset:6656
    v_add_f32 v225, 1.0, v225
    v_rcp_f32 v224, v224
    v_rcp_f32 v225, v225
    s_waitcnt lgkmcnt(4)
    v_mfma_f32_32x32x16_bf16 v[128:143], v[204:207], a[68:71], v[128:143]
    ds_read_b64_tr_b16 v[200:201], v30 offset:8192
    s_add_u32 m0, s58, 132096
    s_add_u32 s98, s57, 2048
    buffer_load_dwordx4 v10, s[16:19], s98 offen lds
    v_mul_f32 v216, v100, v100
    v_mul_f32 v217, v101, v101
    v_mfma_f32_32x32x16_bf16 v[144:159], v[204:207], a[196:199], v[144:159]
    ds_read_b64_tr_b16 v[202:203], v30 offset:8704
    v_mul_f32 v226, v226, v224
    v_mul_f32 v227, v227, v225
    v_cvt_pk_bf16_f32 v209, v226, v227
    v_fmamk_f32 v216, v216, 0xbdd2d3e8, v48
    s_waitcnt lgkmcnt(4)
    v_mfma_f32_32x32x16_bf16 v[128:143], v[192:195], a[72:75], v[128:143]
    ds_read_b64_tr_b16 v[204:205], v30 offset:10240
    v_fmamk_f32 v217, v217, 0xbdd2d3e8, v48
    v_mul_f32 v216, v100, v216
    v_mul_f32 v217, v101, v217
    v_exp_f32 v216, v216
    v_mfma_f32_32x32x16_bf16 v[144:159], v[192:195], a[200:203], v[144:159]
    ds_read_b64_tr_b16 v[206:207], v30 offset:10752
    v_exp_f32 v217, v217
    v_mul_f32 v218, v100, v108
    v_mul_f32 v219, v101, v109
    s_waitcnt lgkmcnt(4)
    v_mfma_f32_32x32x16_bf16 v[128:143], v[196:199], a[76:79], v[128:143]
    ds_read_b64_tr_b16 v[192:193], v30 offset:12288
    v_add_f32 v216, 1.0, v216
    v_add_f32 v217, 1.0, v217
    v_rcp_f32 v216, v216
    v_rcp_f32 v217, v217
    v_mfma_f32_32x32x16_bf16 v[144:159], v[196:199], a[204:207], v[144:159]
    ds_read_b64_tr_b16 v[194:195], v30 offset:12800
    v_mul_f32 v224, v102, v102
    v_mul_f32 v225, v103, v103
    v_mul_f32 v218, v218, v216
    v_mul_f32 v219, v219, v217
    s_waitcnt lgkmcnt(4)
    v_mfma_f32_32x32x16_bf16 v[128:143], v[200:203], a[80:83], v[128:143]
    ds_read_b64_tr_b16 v[196:197], v30 offset:14336
    v_cvt_pk_bf16_f32 v210, v218, v219
    v_fmamk_f32 v224, v224, 0xbdd2d3e8, v48
    v_fmamk_f32 v225, v225, 0xbdd2d3e8, v48
    v_mul_f32 v224, v102, v224
    v_mul_f32 v225, v103, v225
    v_mfma_f32_32x32x16_bf16 v[144:159], v[200:203], a[208:211], v[144:159]
    ds_read_b64_tr_b16 v[198:199], v30 offset:14848
    v_exp_f32 v224, v224
    v_exp_f32 v225, v225
    s_waitcnt lgkmcnt(4)
    v_mfma_f32_32x32x16_bf16 v[128:143], v[204:207], a[84:87], v[128:143]
    v_mul_f32 v226, v102, v110
    v_mul_f32 v227, v103, v111
    v_add_f32 v224, 1.0, v224
    v_add_f32 v225, 1.0, v225
    v_rcp_f32 v224, v224
    v_mfma_f32_32x32x16_bf16 v[144:159], v[204:207], a[212:215], v[144:159]
    v_rcp_f32 v225, v225
    s_nop 0
    v_mul_f32 v226, v226, v224
    v_mul_f32 v227, v227, v225
    v_cvt_pk_bf16_f32 v211, v226, v227
    s_add_u32 s62, s84, 0
    buffer_store_dwordx4 v[208:211], v60, s[24:27], s62 offen sc1
    ds_read_b64 v[236:237], v46 offset:0
    ds_read_b64 v[238:239], v46 offset:256
    ds_read_b64 v[240:241], v46 offset:512
    ds_read_b64 v[242:243], v46 offset:768
    ds_read_b64 v[244:245], v46 offset:16384
    ds_read_b64 v[246:247], v46 offset:16640
    ds_read_b64 v[248:249], v46 offset:16896
    ds_read_b64 v[250:251], v46 offset:17152
    v_mov_b32 v43, 0
    v_mov_b32 v44, 0
    s_waitcnt lgkmcnt(0)
    s_waitcnt vmcnt(3)
    s_barrier
    ds_read_b64_tr_b16 v[200:201], v30 offset:32768
    ds_read_b64_tr_b16 v[202:203], v30 offset:33280
    v_mfma_f32_32x32x16_bf16 v[128:143], v[192:195], a[88:91], v[128:143]
    ds_read_b64_tr_b16 v[204:205], v30 offset:34816
    s_add_u32 m0, s58, 133120
    s_add_u32 s98, s53, 2048
    buffer_load_dwordx4 v9, s[16:19], s98 offen lds
    v_cndmask_b32 v43, v43, v236, s[66:67]
    v_cndmask_b32 v44, v44, v237, s[66:67]
    v_mfma_f32_32x32x16_bf16 v[144:159], v[192:195], a[216:219], v[144:159]
    ds_read_b64_tr_b16 v[206:207], v30 offset:35328
    v_fma_f32 v2, v37, v236, v238
    v_fma_f32 v3, v37, v237, v239
    v_fma_f32 v2, -v38, v237, v2
    v_fma_f32 v3, v38, v236, v3
    v_mfma_f32_32x32x16_bf16 v[128:143], v[196:199], a[92:95], v[128:143]
    ds_read_b64_tr_b16 v[192:193], v30 offset:36864
    v_cndmask_b32 v43, v43, v2, s[68:69]
    v_cndmask_b32 v44, v44, v3, s[68:69]
    v_fma_f32 v4, v37, v2, v240
    v_fma_f32 v5, v37, v3, v241
    v_fma_f32 v4, -v38, v3, v4
    v_mfma_f32_32x32x16_bf16 v[144:159], v[196:199], a[220:223], v[144:159]
    ds_read_b64_tr_b16 v[194:195], v30 offset:37376
    v_fma_f32 v5, v38, v2, v5
    v_cndmask_b32 v43, v43, v4, s[70:71]
    v_cndmask_b32 v44, v44, v5, s[70:71]
    v_fma_f32 v2, v37, v4, v242
    s_waitcnt lgkmcnt(4)
    v_mfma_f32_32x32x16_bf16 v[128:143], v[200:203], a[96:99], v[128:143]
    ds_read_b64_tr_b16 v[196:197], v30 offset:38912
    v_fma_f32 v3, v37, v5, v243
    v_fma_f32 v2, -v38, v5, v2
    v_fma_f32 v3, v38, v4, v3
    v_cndmask_b32 v43, v43, v2, s[72:73]
    v_cndmask_b32 v44, v44, v3, s[72:73]
    v_mfma_f32_32x32x16_bf16 v[144:159], v[200:203], a[224:227], v[144:159]
    ds_read_b64_tr_b16 v[198:199], v30 offset:39424
    v_fma_f32 v4, v37, v2, v244
    v_fma_f32 v5, v37, v3, v245
    v_fma_f32 v4, -v38, v3, v4
    v_fma_f32 v5, v38, v2, v5
    s_waitcnt lgkmcnt(4)
    v_mfma_f32_32x32x16_bf16 v[128:143], v[204:207], a[100:103], v[128:143]
    ds_read_b64_tr_b16 v[200:201], v30 offset:40960
    v_cndmask_b32 v43, v43, v4, s[74:75]
    v_cndmask_b32 v44, v44, v5, s[74:75]
    v_fma_f32 v2, v37, v4, v246
    v_fma_f32 v3, v37, v5, v247
    v_fma_f32 v2, -v38, v5, v2
    v_mfma_f32_32x32x16_bf16 v[144:159], v[204:207], a[228:231], v[144:159]
    ds_read_b64_tr_b16 v[202:203], v30 offset:41472
    v_fma_f32 v3, v38, v4, v3
    v_cndmask_b32 v43, v43, v2, s[76:77]
    v_cndmask_b32 v44, v44, v3, s[76:77]
    v_fma_f32 v4, v37, v2, v248
    s_waitcnt lgkmcnt(4)
    v_mfma_f32_32x32x16_bf16 v[128:143], v[192:195], a[104:107], v[128:143]
    ds_read_b64_tr_b16 v[204:205], v30 offset:43008
    v_fma_f32 v5, v37, v3, v249
    v_fma_f32 v4, -v38, v3, v4
    v_fma_f32 v5, v38, v2, v5
    v_cndmask_b32 v43, v43, v4, s[78:79]
    v_cndmask_b32 v44, v44, v5, s[78:79]
    v_mfma_f32_32x32x16_bf16 v[144:159], v[192:195], a[232:235], v[144:159]
    ds_read_b64_tr_b16 v[206:207], v30 offset:43520
    v_fma_f32 v2, v37, v4, v250
    v_fma_f32 v3, v37, v5, v251
    v_fma_f32 v2, -v38, v5, v2
    v_fma_f32 v3, v38, v4, v3
    s_waitcnt lgkmcnt(4)
    v_mfma_f32_32x32x16_bf16 v[128:143], v[196:199], a[108:111], v[128:143]
    ds_read_b64_tr_b16 v[192:193], v30 offset:45056
    s_add_u32 m0, s59, 131072
    s_add_u32 s98, s57, 3072
    buffer_load_dwordx4 v13, s[20:23], s98 offen lds
    v_cmp_gt_u32 vcc, 32, v1
    v_mov_b32 v7, s101
    s_nop 0
    v_cndmask_b32 v6, v3, v2, vcc
    buffer_store_dwordx2 v[6:7], v51, s[24:27], 0 offen sc1
    v_mfma_f32_32x32x16_bf16 v[144:159], v[196:199], a[236:239], v[144:159]
    ds_read_b64_tr_b16 v[194:195], v30 offset:45568
    v_mul_f32 v216, v112, v112
    v_mul_f32 v217, v113, v113
    v_fmamk_f32 v216, v216, 0xbdd2d3e8, v48
    v_fmamk_f32 v217, v217, 0xbdd2d3e8, v48
    s_waitcnt lgkmcnt(4)
    v_mfma_f32_32x32x16_bf16 v[128:143], v[200:203], a[112:115], v[128:143]
    ds_read_b64_tr_b16 v[196:197], v30 offset:47104
    v_mul_f32 v216, v112, v216
    v_mul_f32 v217, v113, v217
    v_exp_f32 v216, v216
    v_exp_f32 v217, v217
    v_mfma_f32_32x32x16_bf16 v[144:159], v[200:203], a[240:243], v[144:159]
    ds_read_b64_tr_b16 v[198:199], v30 offset:47616
    v_mul_f32 v218, v112, v120
    v_mul_f32 v219, v113, v121
    v_add_f32 v216, 1.0, v216
    v_add_f32 v217, 1.0, v217
    s_waitcnt lgkmcnt(4)
    v_mfma_f32_32x32x16_bf16 v[128:143], v[204:207], a[116:119], v[128:143]
    ds_read_b64_tr_b16 v[200:201], v47 offset:0
    v_rcp_f32 v216, v216
    v_rcp_f32 v217, v217
    v_mul_f32 v224, v114, v114
    v_mfma_f32_32x32x16_bf16 v[144:159], v[204:207], a[244:247], v[144:159]
    ds_read_b64_tr_b16 v[202:203], v47 offset:512
    v_mul_f32 v225, v115, v115
    v_mul_f32 v218, v218, v216
    v_mul_f32 v219, v219, v217
    v_cvt_pk_bf16_f32 v212, v218, v219
    s_waitcnt lgkmcnt(4)
    v_mfma_f32_32x32x16_bf16 v[128:143], v[192:195], a[120:123], v[128:143]
    ds_read_b64_tr_b16 v[204:205], v47 offset:2048
    v_fmamk_f32 v224, v224, 0xbdd2d3e8, v48
    v_fmamk_f32 v225, v225, 0xbdd2d3e8, v48
    v_mul_f32 v224, v114, v224
    v_mul_f32 v225, v115, v225
    v_exp_f32 v224, v224
    v_mfma_f32_32x32x16_bf16 v[144:159], v[192:195], a[248:251], v[144:159]
    ds_read_b64_tr_b16 v[206:207], v47 offset:2560
    v_exp_f32 v225, v225
    v_mul_f32 v226, v114, v122
    v_mul_f32 v227, v115, v123
    s_waitcnt lgkmcnt(4)
    v_mfma_f32_32x32x16_bf16 v[128:143], v[196:199], a[124:127], v[128:143]
    ds_read_b64_tr_b16 v[192:193], v47 offset:4096
    v_add_f32 v224, 1.0, v224
    v_add_f32 v225, 1.0, v225
    v_rcp_f32 v224, v224
    v_rcp_f32 v225, v225
    v_mfma_f32_32x32x16_bf16 v[144:159], v[196:199], a[252:255], v[144:159]
    ds_read_b64_tr_b16 v[194:195], v47 offset:4608
    v_mul_f32 v216, v116, v116
    v_mul_f32 v217, v117, v117
    v_mul_f32 v226, v226, v224
    v_mul_f32 v227, v227, v225
    s_waitcnt lgkmcnt(4)
    v_mfma_f32_32x32x16_bf16 v[160:175], v[200:203], a[0:3], 0
    ds_read_b64_tr_b16 v[196:197], v47 offset:6144
    s_add_u32 m0, s59, 132096
    s_add_u32 s98, s57, 3072
    buffer_load_dwordx4 v14, s[20:23], s98 offen lds
    v_cvt_pk_bf16_f32 v213, v226, v227
    v_fmamk_f32 v216, v216, 0xbdd2d3e8, v48
    v_mfma_f32_32x32x16_bf16 v[176:191], v[200:203], a[128:131], 0
    ds_read_b64_tr_b16 v[198:199], v47 offset:6656
    v_fmamk_f32 v217, v217, 0xbdd2d3e8, v48
    v_mul_f32 v216, v116, v216
    v_mul_f32 v217, v117, v217
    v_exp_f32 v216, v216
    s_waitcnt lgkmcnt(4)
    v_mfma_f32_32x32x16_bf16 v[160:175], v[204:207], a[4:7], v[160:175]
    ds_read_b64_tr_b16 v[200:201], v47 offset:8192
    v_exp_f32 v217, v217
    v_mul_f32 v218, v116, v124
    v_mul_f32 v219, v117, v125
    v_add_f32 v216, 1.0, v216
    v_mfma_f32_32x32x16_bf16 v[176:191], v[204:207], a[132:135], v[176:191]
    ds_read_b64_tr_b16 v[202:203], v47 offset:8704
    v_add_f32 v217, 1.0, v217
    v_rcp_f32 v216, v216
    v_rcp_f32 v217, v217
    s_waitcnt lgkmcnt(4)
    v_mfma_f32_32x32x16_bf16 v[160:175], v[192:195], a[8:11], v[160:175]
    ds_read_b64_tr_b16 v[204:205], v47 offset:10240
    v_mul_f32 v224, v118, v118
    v_mul_f32 v225, v119, v119
    v_mul_f32 v218, v218, v216
    v_mul_f32 v219, v219, v217
    v_cvt_pk_bf16_f32 v214, v218, v219
    v_mfma_f32_32x32x16_bf16 v[176:191], v[192:195], a[136:139], v[176:191]
    ds_read_b64_tr_b16 v[206:207], v47 offset:10752
    v_fmamk_f32 v224, v224, 0xbdd2d3e8, v48
    v_fmamk_f32 v225, v225, 0xbdd2d3e8, v48
    v_mul_f32 v224, v118, v224
    v_mul_f32 v225, v119, v225
    s_waitcnt lgkmcnt(4)
    v_mfma_f32_32x32x16_bf16 v[160:175], v[196:199], a[12:15], v[160:175]
    ds_read_b64_tr_b16 v[192:193], v47 offset:12288
    v_exp_f32 v224, v224
    v_exp_f32 v225, v225
    v_mul_f32 v226, v118, v126
    v_mfma_f32_32x32x16_bf16 v[176:191], v[196:199], a[140:143], v[176:191]
    ds_read_b64_tr_b16 v[194:195], v47 offset:12800
    v_mul_f32 v227, v119, v127
    v_add_f32 v224, 1.0, v224
    v_add_f32 v225, 1.0, v225
    v_rcp_f32 v224, v224
    s_waitcnt lgkmcnt(4)
    v_mfma_f32_32x32x16_bf16 v[160:175], v[200:203], a[16:19], v[160:175]
    ds_read_b64_tr_b16 v[196:197], v47 offset:14336
    v_rcp_f32 v225, v225
    s_nop 0
    v_mul_f32 v226, v226, v224
    v_mul_f32 v227, v227, v225
    v_mfma_f32_32x32x16_bf16 v[176:191], v[200:203], a[144:147], v[176:191]
    ds_read_b64_tr_b16 v[198:199], v47 offset:14848
    v_cvt_pk_bf16_f32 v215, v226, v227
    s_add_u32 s62, s85, 0
    buffer_store_dwordx4 v[212:215], v60, s[24:27], s62 offen sc1
    v_mul_f32 v216, v128, v128
    s_waitcnt lgkmcnt(4)
    v_mfma_f32_32x32x16_bf16 v[160:175], v[204:207], a[20:23], v[160:175]
    ds_read_b64_tr_b16 v[200:201], v47 offset:32768
    s_add_u32 m0, s59, 133120
    s_add_u32 s98, s53, 3072
    buffer_load_dwordx4 v13, s[20:23], s98 offen lds
    v_mul_f32 v217, v129, v129
    v_fmamk_f32 v216, v216, 0xbdd2d3e8, v48
    v_mfma_f32_32x32x16_bf16 v[176:191], v[204:207], a[148:151], v[176:191]
    ds_read_b64_tr_b16 v[202:203], v47 offset:33280
    v_fmamk_f32 v217, v217, 0xbdd2d3e8, v48
    v_mul_f32 v216, v128, v216
    v_mul_f32 v217, v129, v217
    v_exp_f32 v216, v216
    s_waitcnt lgkmcnt(4)
    v_mfma_f32_32x32x16_bf16 v[160:175], v[192:195], a[24:27], v[160:175]
    ds_read_b64_tr_b16 v[204:205], v47 offset:34816
    v_exp_f32 v217, v217
    v_mul_f32 v218, v128, v136
    v_mul_f32 v219, v129, v137
    v_add_f32 v216, 1.0, v216
    v_mfma_f32_32x32x16_bf16 v[176:191], v[192:195], a[152:155], v[176:191]
    ds_read_b64_tr_b16 v[206:207], v47 offset:35328
    v_add_f32 v217, 1.0, v217
    v_rcp_f32 v216, v216
    v_rcp_f32 v217, v217
    s_waitcnt lgkmcnt(4)
    v_mfma_f32_32x32x16_bf16 v[160:175], v[196:199], a[28:31], v[160:175]
    ds_read_b64_tr_b16 v[192:193], v47 offset:36864
    v_mul_f32 v224, v130, v130
    v_mul_f32 v225, v131, v131
    v_mul_f32 v218, v218, v216
    v_mul_f32 v219, v219, v217
    v_cvt_pk_bf16_f32 v208, v218, v219
    v_mfma_f32_32x32x16_bf16 v[176:191], v[196:199], a[156:159], v[176:191]
    ds_read_b64_tr_b16 v[194:195], v47 offset:37376
    v_fmamk_f32 v224, v224, 0xbdd2d3e8, v48
    v_fmamk_f32 v225, v225, 0xbdd2d3e8, v48
    v_mul_f32 v224, v130, v224
    v_mul_f32 v225, v131, v225
    s_waitcnt lgkmcnt(4)
    v_mfma_f32_32x32x16_bf16 v[160:175], v[200:203], a[32:35], v[160:175]
    ds_read_b64_tr_b16 v[196:197], v47 offset:38912
    v_exp_f32 v224, v224
    v_exp_f32 v225, v225
    v_mul_f32 v226, v130, v138
    v_mfma_f32_32x32x16_bf16 v[176:191], v[200:203], a[160:163], v[176:191]
    ds_read_b64_tr_b16 v[198:199], v47 offset:39424
    v_mul_f32 v227, v131, v139
    v_add_f32 v224, 1.0, v224
    v_add_f32 v225, 1.0, v225
    v_rcp_f32 v224, v224
    s_waitcnt lgkmcnt(4)
    v_mfma_f32_32x32x16_bf16 v[160:175], v[204:207], a[36:39], v[160:175]
    ds_read_b64_tr_b16 v[200:201], v47 offset:40960
    v_rcp_f32 v225, v225
    v_mul_f32 v216, v132, v132
    v_mul_f32 v217, v133, v133
    v_mul_f32 v226, v226, v224
    v_mfma_f32_32x32x16_bf16 v[176:191], v[204:207], a[164:167], v[176:191]
    ds_read_b64_tr_b16 v[202:203], v47 offset:41472
    v_mul_f32 v227, v227, v225
    v_cvt_pk_bf16_f32 v209, v226, v227
    v_fmamk_f32 v216, v216, 0xbdd2d3e8, v48
    v_fmamk_f32 v217, v217, 0xbdd2d3e8, v48
    v_and_b32 v24, 15, v1
    v_lshlrev_b32 v24, 4, v24
    v_bfe_u32 v26, v1, 4, 1
    v_add_u32 v24, v24, v26
    s_lshl_b32 s62, s82, 1
    v_add_u32 v24, s62, v24
    v_lshlrev_b32 v24, 7, v24
    v_add_u32 v24, 15990784, v24
    buffer_load_dword v25, v24, s[24:27], 0 offen sc1
    s_lshl_b32 s62, s51, 10
    v_add_u32 v45, s62, v60
    v_xor_b32 v46, 0x400, v45
    s_mul_i32 s63, s82, 360448
    s_add_u32 s63, s63, 12582912
    s_lshl_b32 s62, s83, 2
    s_add_u32 s62, s62, s50
    s_lshl_b32 s62, s62, 14
    s_add_u32 s3, s63, s62
    s_lshl_b32 s62, s83, 1
    s_add_u32 s62, s62, s52
    s_mul_i32 s62, s62, 57344
    s_add_u32 s63, s63, s62
    s_add_u32 s63, s63, 131072
    s_mul_i32 s62, s51, 16384
    s_add_u32 s92, s63, s62
    s_mul_i32 s62, s51, 12288
    s_add_u32 s93, s63, s62
    s_waitcnt lgkmcnt(4)
    v_mfma_f32_32x32x16_bf16 v[160:175], v[192:195], a[40:43], v[160:175]
    ds_read_b64_tr_b16 v[204:205], v47 offset:43008
    s_add_u32 m0, s58, 134144
    s_add_u32 s98, s53, 2048
    buffer_load_dwordx4 v10, s[16:19], s98 offen lds
    v_mul_f32 v216, v132, v216
    v_mul_f32 v217, v133, v217
    v_mfma_f32_32x32x16_bf16 v[176:191], v[192:195], a[168:171], v[176:191]
    ds_read_b64_tr_b16 v[206:207], v47 offset:43520
    v_exp_f32 v216, v216
    v_exp_f32 v217, v217
    s_waitcnt lgkmcnt(4)
    v_mfma_f32_32x32x16_bf16 v[160:175], v[196:199], a[44:47], v[160:175]
    ds_read_b64_tr_b16 v[192:193], v47 offset:45056
    v_mul_f32 v218, v132, v140
    v_mul_f32 v219, v133, v141
    v_add_f32 v216, 1.0, v216
    v_add_f32 v217, 1.0, v217
    v_rcp_f32 v216, v216
    v_mfma_f32_32x32x16_bf16 v[176:191], v[196:199], a[172:175], v[176:191]
    ds_read_b64_tr_b16 v[194:195], v47 offset:45568
    v_rcp_f32 v217, v217
    v_mul_f32 v224, v134, v134
    v_mul_f32 v225, v135, v135
    s_waitcnt lgkmcnt(4)
    v_mfma_f32_32x32x16_bf16 v[160:175], v[200:203], a[48:51], v[160:175]
    ds_read_b64_tr_b16 v[196:197], v47 offset:47104
    v_mul_f32 v218, v218, v216
    v_mul_f32 v219, v219, v217
    v_cvt_pk_bf16_f32 v210, v218, v219
    v_fmamk_f32 v224, v224, 0xbdd2d3e8, v48
    v_fmamk_f32 v225, v225, 0xbdd2d3e8, v48
    v_mfma_f32_32x32x16_bf16 v[176:191], v[200:203], a[176:179], v[176:191]
    ds_read_b64_tr_b16 v[198:199], v47 offset:47616
    v_mul_f32 v224, v134, v224
    v_mul_f32 v225, v135, v225
    v_exp_f32 v224, v224
    s_waitcnt lgkmcnt(4)
    v_mfma_f32_32x32x16_bf16 v[160:175], v[204:207], a[52:55], v[160:175]
    v_xor_b32 v47, 0x10000, v47
    ds_read_b64_tr_b16 v[200:201], v47 offset:0
    v_exp_f32 v225, v225
    v_mul_f32 v226, v134, v142
    v_mul_f32 v227, v135, v143
    v_mfma_f32_32x32x16_bf16 v[176:191], v[204:207], a[180:183], v[176:191]
    ds_read_b64_tr_b16 v[202:203], v47 offset:512
    v_add_f32 v224, 1.0, v224
    v_add_f32 v225, 1.0, v225
    v_rcp_f32 v224, v224
    s_waitcnt lgkmcnt(4)
    v_mfma_f32_32x32x16_bf16 v[160:175], v[192:195], a[56:59], v[160:175]
    ds_read_b64_tr_b16 v[204:205], v47 offset:2048
    v_rcp_f32 v225, v225
    s_nop 0
    v_mul_f32 v226, v226, v224
    v_mul_f32 v227, v227, v225
    v_mfma_f32_32x32x16_bf16 v[176:191], v[192:195], a[184:187], v[176:191]
    ds_read_b64_tr_b16 v[206:207], v47 offset:2560
    v_cvt_pk_bf16_f32 v211, v226, v227
    s_add_u32 s62, s94, 0
    buffer_store_dwordx4 v[208:211], v60, s[24:27], s62 offen sc1
    v_mul_f32 v216, v144, v144
    s_waitcnt lgkmcnt(4)
    v_mfma_f32_32x32x16_bf16 v[160:175], v[196:199], a[60:63], v[160:175]
    ds_read_b64_tr_b16 v[192:193], v47 offset:4096
    s_add_u32 m0, s59, 134144
    s_add_u32 s98, s53, 3072
    buffer_load_dwordx4 v14, s[20:23], s98 offen lds
    v_mul_f32 v217, v145, v145
    v_fmamk_f32 v216, v216, 0xbdd2d3e8, v48
    v_mfma_f32_32x32x16_bf16 v[176:191], v[196:199], a[188:191], v[176:191]
    ds_read_b64_tr_b16 v[194:195], v47 offset:4608
    v_fmamk_f32 v217, v217, 0xbdd2d3e8, v48
    v_mul_f32 v216, v144, v216
    v_mul_f32 v217, v145, v217
    v_exp_f32 v216, v216
    s_waitcnt lgkmcnt(4)
    v_mfma_f32_32x32x16_bf16 v[160:175], v[200:203], a[64:67], v[160:175]
    ds_read_b64_tr_b16 v[196:197], v47 offset:6144
    v_exp_f32 v217, v217
    v_mul_f32 v218, v144, v152
    v_mul_f32 v219, v145, v153
    v_add_f32 v216, 1.0, v216
    v_mfma_f32_32x32x16_bf16 v[176:191], v[200:203], a[192:195], v[176:191]
    ds_read_b64_tr_b16 v[198:199], v47 offset:6656
    v_add_f32 v217, 1.0, v217
    v_rcp_f32 v216, v216
    v_rcp_f32 v217, v217
    s_waitcnt lgkmcnt(4)
    v_mfma_f32_32x32x16_bf16 v[160:175], v[204:207], a[68:71], v[160:175]
    ds_read_b64_tr_b16 v[200:201], v47 offset:8192
    v_mul_f32 v224, v146, v146
    v_mul_f32 v225, v147, v147
    v_mul_f32 v218, v218, v216
    v_mul_f32 v219, v219, v217
    v_cvt_pk_bf16_f32 v212, v218, v219
    v_mfma_f32_32x32x16_bf16 v[176:191], v[204:207], a[196:199], v[176:191]
    ds_read_b64_tr_b16 v[202:203], v47 offset:8704
    v_fmamk_f32 v224, v224, 0xbdd2d3e8, v48
    v_fmamk_f32 v225, v225, 0xbdd2d3e8, v48
    v_mul_f32 v224, v146, v224
    v_mul_f32 v225, v147, v225
    s_lshl_b32 s62, s50, 2
    s_add_u32 s62, s62, s48
    s_sub_u32 s63, s62, 12
    s_max_i32 s63, s63, 0
    s_min_i32 s65, s63, 4
    s_sub_u32 s62, s62, 16
    s_lshl_b32 s62, s62, 13
    s_lshl_b32 s63, s49, 9
    s_add_u32 s62, s62, s63
    v_lshl_add_u32 v23, v1, 3, s62
    s_mov_b32 s32, s24
    s_mov_b32 s33, s25
    s_add_u32 s32, s32, 15794176
    s_addc_u32 s33, s33, 0
    s_mov_b32 s34, 131072
    s_mov_b32 s35, 0x20000
    v_mov_b32 v27, v23
    s_waitcnt lgkmcnt(4)
    v_mfma_f32_32x32x16_bf16 v[160:175], v[192:195], a[72:75], v[160:175]
    ds_read_b64_tr_b16 v[204:205], v47 offset:10240
    buffer_load_dwordx2 v[228:229], v27, s[32:35], 0 offen sc1
    v_add_u32 v27, 0x2000, v27
    v_exp_f32 v224, v224
    v_exp_f32 v225, v225
    v_mfma_f32_32x32x16_bf16 v[176:191], v[192:195], a[200:203], v[176:191]
    ds_read_b64_tr_b16 v[206:207], v47 offset:10752
    buffer_load_dwordx2 v[230:231], v27, s[32:35], 0 offen sc1
    v_add_u32 v27, 0x2000, v27
    v_mul_f32 v226, v146, v154
    v_mul_f32 v227, v147, v155
    s_waitcnt lgkmcnt(4)
    v_mfma_f32_32x32x16_bf16 v[160:175], v[196:199], a[76:79], v[160:175]
    ds_read_b64_tr_b16 v[192:193], v47 offset:12288
    buffer_load_dwordx2 v[232:233], v27, s[32:35], 0 offen sc1
    v_add_u32 v27, 0x2000, v27
    v_add_f32 v224, 1.0, v224
    v_add_f32 v225, 1.0, v225
    v_rcp_f32 v224, v224
    v_mfma_f32_32x32x16_bf16 v[176:191], v[196:199], a[204:207], v[176:191]
    ds_read_b64_tr_b16 v[194:195], v47 offset:12800
    buffer_load_dwordx2 v[234:235], v27, s[32:35], 0 offen sc1
    v_rcp_f32 v225, v225
    v_mul_f32 v216, v148, v148
    s_waitcnt vmcnt(7)
gated_mix__ssm_conv_s5__glu_gated_geglu__prompt_kernel_chk_wf:
    v_cmp_eq_u32 vcc, s101, v25
    s_and_b32 s60, vcc_lo, -1
    s_cmp_eq_u32 s60, -1
    s_cbranch_scc0 gated_mix__ssm_conv_s5__glu_gated_geglu__prompt_kernel_spin_wf
gated_mix__ssm_conv_s5__glu_gated_geglu__prompt_kernel_ok_wf:
    s_waitcnt lgkmcnt(4)
    v_mfma_f32_32x32x16_bf16 v[160:175], v[200:203], a[80:83], v[160:175]
    ds_read_b64_tr_b16 v[196:197], v47 offset:14336
    s_add_u32 s62, s92, 0
    buffer_load_dwordx4 a[128:131], v45, s[24:27], s62 offen sc1
    buffer_load_dwordx4 a[132:135], v46, s[24:27], s62 offen sc1
    v_mul_f32 v217, v149, v149
    v_mul_f32 v226, v226, v224
    v_mfma_f32_32x32x16_bf16 v[176:191], v[200:203], a[208:211], v[176:191]
    ds_read_b64_tr_b16 v[198:199], v47 offset:14848
    v_mul_f32 v227, v227, v225
    v_cvt_pk_bf16_f32 v213, v226, v227
    v_fmamk_f32 v216, v216, 0xbdd2d3e8, v48
    v_fmamk_f32 v217, v217, 0xbdd2d3e8, v48
    s_waitcnt lgkmcnt(4)
    v_mfma_f32_32x32x16_bf16 v[160:175], v[204:207], a[84:87], v[160:175]
    ds_read_b64_tr_b16 v[200:201], v47 offset:32768
    v_mul_f32 v216, v148, v216
    v_mul_f32 v217, v149, v217
    v_exp_f32 v216, v216
    v_exp_f32 v217, v217
    v_mfma_f32_32x32x16_bf16 v[176:191], v[204:207], a[212:215], v[176:191]
    ds_read_b64_tr_b16 v[202:203], v47 offset:33280
    v_mul_f32 v218, v148, v156
    v_mul_f32 v219, v149, v157
    v_add_f32 v216, 1.0, v216
    v_add_f32 v217, 1.0, v217
    s_waitcnt lgkmcnt(4)
    v_mfma_f32_32x32x16_bf16 v[160:175], v[192:195], a[88:91], v[160:175]
    ds_read_b64_tr_b16 v[204:205], v47 offset:34816
    s_add_u32 s62, s92, 2048
    buffer_load_dwordx4 a[136:139], v45, s[24:27], s62 offen sc1
    buffer_load_dwordx4 a[140:143], v46, s[24:27], s62 offen sc1
    v_rcp_f32 v216, v216
    v_mfma_f32_32x32x16_bf16 v[176:191], v[192:195], a[216:219], v[176:191]
    ds_read_b64_tr_b16 v[206:207], v47 offset:35328
    v_rcp_f32 v217, v217
    v_mul_f32 v224, v150, v150
    v_mul_f32 v225, v151, v151
    s_waitcnt lgkmcnt(4)
    v_mfma_f32_32x32x16_bf16 v[160:175], v[196:199], a[92:95], v[160:175]
    ds_read_b64_tr_b16 v[192:193], v47 offset:36864
    v_mul_f32 v218, v218, v216
    v_mul_f32 v219, v219, v217
    v_cvt_pk_bf16_f32 v214, v218, v219
    v_fmamk_f32 v224, v224, 0xbdd2d3e8, v48
    v_fmamk_f32 v225, v225, 0xbdd2d3e8, v48
    v_mfma_f32_32x32x16_bf16 v[176:191], v[196:199], a[220:223], v[176:191]
    ds_read_b64_tr_b16 v[194:195], v47 offset:37376
    v_mul_f32 v224, v150, v224
    v_mul_f32 v225, v151, v225
    v_exp_f32 v224, v224
    s_waitcnt lgkmcnt(4)
    v_mfma_f32_32x32x16_bf16 v[160:175], v[200:203], a[96:99], v[160:175]
    ds_read_b64_tr_b16 v[196:197], v47 offset:38912
    s_add_u32 s62, s92, 8192
    buffer_load_dwordx4 a[144:147], v45, s[24:27], s62 offen sc1
    buffer_load_dwordx4 a[148:151], v46, s[24:27], s62 offen sc1
    v_exp_f32 v225, v225
    v_mfma_f32_32x32x16_bf16 v[176:191], v[200:203], a[224:227], v[176:191]
    ds_read_b64_tr_b16 v[198:199], v47 offset:39424
    v_mul_f32 v226, v150, v158
    v_mul_f32 v227, v151, v159
    v_add_f32 v224, 1.0, v224
    v_add_f32 v225, 1.0, v225
    s_waitcnt lgkmcnt(4)
    v_mfma_f32_32x32x16_bf16 v[160:175], v[204:207], a[100:103], v[160:175]
    ds_read_b64_tr_b16 v[200:201], v47 offset:40960
    v_rcp_f32 v224, v224
    v_rcp_f32 v225, v225
    s_nop 0
    v_mfma_f32_32x32x16_bf16 v[176:191], v[204:207], a[228:231], v[176:191]
    ds_read_b64_tr_b16 v[202:203], v47 offset:41472
    v_mul_f32 v226, v226, v224
    v_mul_f32 v227, v227, v225
    v_cvt_pk_bf16_f32 v215, v226, v227
    s_add_u32 s62, s95, 0
    buffer_store_dwordx4 v[212:215], v60, s[24:27], s62 offen sc1
    s_waitcnt lgkmcnt(4)
    v_mfma_f32_32x32x16_bf16 v[160:175], v[192:195], a[104:107], v[160:175]
    ds_read_b64_tr_b16 v[204:205], v47 offset:43008
    s_add_u32 s62, s92, 10240
    buffer_load_dwordx4 a[152:155], v45, s[24:27], s62 offen sc1
    buffer_load_dwordx4 a[156:159], v46, s[24:27], s62 offen sc1
    v_mfma_f32_32x32x16_bf16 v[176:191], v[192:195], a[232:235], v[176:191]
    ds_read_b64_tr_b16 v[206:207], v47 offset:43520
    s_waitcnt lgkmcnt(4)
    v_mfma_f32_32x32x16_bf16 v[160:175], v[196:199], a[108:111], v[160:175]
    ds_read_b64_tr_b16 v[192:193], v47 offset:45056
    v_mfma_f32_32x32x16_bf16 v[176:191], v[196:199], a[236:239], v[176:191]
    ds_read_b64_tr_b16 v[194:195], v47 offset:45568
    s_waitcnt lgkmcnt(4)
    v_mfma_f32_32x32x16_bf16 v[160:175], v[200:203], a[112:115], v[160:175]
    ds_read_b64_tr_b16 v[196:197], v47 offset:47104
    s_add_u32 s62, s93, 32768
    buffer_load_dwordx4 a[160:163], v45, s[24:27], s62 offen sc1
    buffer_load_dwordx4 a[164:167], v46, s[24:27], s62 offen sc1
    v_mfma_f32_32x32x16_bf16 v[176:191], v[200:203], a[240:243], v[176:191]
    ds_read_b64_tr_b16 v[198:199], v47 offset:47616
    s_waitcnt lgkmcnt(4)
    v_mfma_f32_32x32x16_bf16 v[160:175], v[204:207], a[116:119], v[160:175]
    v_mfma_f32_32x32x16_bf16 v[176:191], v[204:207], a[244:247], v[176:191]
    s_waitcnt lgkmcnt(0)
    s_waitcnt vmcnt(15)
    s_barrier
    ds_read_b64_tr_b16 v[200:201], v31 offset:0
    ds_read_b64_tr_b16 v[202:203], v32 offset:0
    v_mfma_f32_32x32x16_bf16 v[160:175], v[192:195], a[120:123], v[160:175]
    ds_read_b64_tr_b16 v[204:205], v31 offset:512
    s_add_u32 s62, s93, 34816
    buffer_load_dwordx4 a[168:171], v45, s[24:27], s62 offen sc1
    buffer_load_dwordx4 a[172:175], v46, s[24:27], s62 offen sc1
    v_mfma_f32_32x32x16_bf16 v[176:191], v[192:195], a[248:251], v[176:191]
    ds_read_b64_tr_b16 v[206:207], v32 offset:512
    v_mfma_f32_32x32x16_bf16 v[160:175], v[196:199], a[124:127], v[160:175]
    ds_read_b64_tr_b16 v[192:193], v31 offset:1024
    v_mfma_f32_32x32x16_bf16 v[176:191], v[196:199], a[252:255], v[176:191]
    ds_read_b64_tr_b16 v[194:195], v32 offset:1024
    v_mov_b32 v56, 0xc0135761
    v_mov_b32 v57, 0xbdd2d3e8
    s_waitcnt lgkmcnt(4)
    v_mfma_f32_32x32x16_bf16 v[96:111], v[200:203], a[0:3], 0
    ds_read_b64_tr_b16 v[196:197], v31 offset:1536
    ds_read_b64_tr_b16 v[198:199], v32 offset:1536
    s_waitcnt lgkmcnt(4)
    v_mfma_f32_32x32x16_bf16 v[96:111], v[204:207], a[4:7], v[96:111]
    ds_read_b64_tr_b16 v[200:201], v31 offset:2048
    ds_read_b64_tr_b16 v[202:203], v32 offset:2048
    s_add_u32 s62, s93, 40960
    buffer_load_dwordx4 a[176:179], v45, s[24:27], s62 offen sc1
    buffer_load_dwordx4 a[180:183], v46, s[24:27], s62 offen sc1
    s_waitcnt lgkmcnt(4)
    v_mfma_f32_32x32x16_bf16 v[96:111], v[192:195], a[8:11], v[96:111]
    ds_read_b64_tr_b16 v[204:205], v31 offset:2560
    ds_read_b64_tr_b16 v[206:207], v32 offset:2560
    v_mul_f32 v28, v40, v40
    v_mul_f32 v8, v39, v40
    v_fma_f32 v58, v39, v39, -v28
    s_waitcnt lgkmcnt(4)
    v_mfma_f32_32x32x16_bf16 v[96:111], v[196:199], a[12:15], v[96:111]
    ds_read_b64_tr_b16 v[192:193], v31 offset:3072
    ds_read_b64_tr_b16 v[194:195], v32 offset:3072
    v_add_f32 v59, v8, v8
    v_mul_f32 v28, v59, v59
    v_mul_f32 v8, v58, v59
    s_waitcnt lgkmcnt(4)
    v_mfma_f32_32x32x16_bf16 v[96:111], v[200:203], a[16:19], v[96:111]
    ds_read_b64_tr_b16 v[196:197], v31 offset:3584
    ds_read_b64_tr_b16 v[198:199], v32 offset:3584
    s_add_u32 s62, s93, 43008
    buffer_load_dwordx4 a[184:187], v45, s[24:27], s62 offen sc1
    buffer_load_dwordx4 a[188:191], v46, s[24:27], s62 offen sc1
    s_waitcnt lgkmcnt(4)
    v_mfma_f32_32x32x16_bf16 v[96:111], v[204:207], a[20:23], v[96:111]
    ds_read_b64_tr_b16 v[200:201], v31 offset:4096
    ds_read_b64_tr_b16 v[202:203], v32 offset:4096
    v_fma_f32 v58, v58, v58, -v28
    v_add_f32 v59, v8, v8
    s_waitcnt vmcnt(17)
gated_mix__ssm_conv_s5__glu_gated_geglu__prompt_kernel_chk_lb:
    v_mov_b32 v28, 0
    v_mov_b32 v8, 0
    v_cmp_eq_u32 s[60:61], s101, v229
    v_cmp_eq_u32 s[62:63], s101, v231
    v_cmp_eq_u32 vcc, s101, v233
    v_addc_co_u32 v28, s[60:61], v28, v8, s[60:61]
    v_cmp_eq_u32 s[60:61], s101, v235
    v_addc_co_u32 v28, s[62:63], v28, v8, s[62:63]
    s_nop 0
    v_addc_co_u32 v28, vcc, v28, v8, vcc
    v_addc_co_u32 v28, s[60:61], v28, v8, s[60:61]
    v_cmp_eq_u32 vcc, s65, v28
    s_cmp_eq_u64 vcc, -1
    s_cbranch_scc0 gated_mix__ssm_conv_s5__glu_gated_geglu__prompt_kernel_spin_lb
gated_mix__ssm_conv_s5__glu_gated_geglu__prompt_kernel_ok_lb:
    s_waitcnt lgkmcnt(4)
    v_mfma_f32_32x32x16_bf16 v[96:111], v[192:195], a[24:27], v[96:111]
    ds_read_b64_tr_b16 v[204:205], v31 offset:4608
    ds_read_b64_tr_b16 v[206:207], v32 offset:4608
    v_mov_b32 v229, v228
    v_mov_b32 v231, v230
    v_mov_b32 v233, v232
    s_waitcnt lgkmcnt(4)
    v_mfma_f32_32x32x16_bf16 v[96:111], v[196:199], a[28:31], v[96:111]
    ds_read_b64_tr_b16 v[192:193], v31 offset:5120
    ds_read_b64_tr_b16 v[194:195], v32 offset:5120
    s_add_u32 s62, s3, 0
    buffer_load_dwordx4 a[192:195], v45, s[24:27], s62 offen sc1
    buffer_load_dwordx4 a[196:199], v46, s[24:27], s62 offen sc1
    s_waitcnt lgkmcnt(4)
    v_mfma_f32_32x32x16_bf16 v[96:111], v[200:203], a[32:35], v[96:111]
    ds_read_b64_tr_b16 v[196:197], v31 offset:5632
    ds_read_b64_tr_b16 v[198:199], v32 offset:5632
    v_mov_b32 v235, v234
    s_nop 0
    v_permlane32_swap_b32 v228, v229
    s_waitcnt lgkmcnt(4)
    v_mfma_f32_32x32x16_bf16 v[96:111], v[204:207], a[36:39], v[96:111]
    ds_read_b64_tr_b16 v[200:201], v31 offset:6144
    ds_read_b64_tr_b16 v[202:203], v32 offset:6144
    v_permlane32_swap_b32 v230, v231
    v_permlane32_swap_b32 v232, v233
    v_permlane32_swap_b32 v234, v235
    s_waitcnt lgkmcnt(4)
    v_mfma_f32_32x32x16_bf16 v[96:111], v[192:195], a[40:43], v[96:111]
    ds_read_b64_tr_b16 v[204:205], v31 offset:6656
    ds_read_b64_tr_b16 v[206:207], v32 offset:6656
    s_add_u32 s62, s3, 2048
    buffer_load_dwordx4 a[200:203], v45, s[24:27], s62 offen sc1
    buffer_load_dwordx4 a[204:207], v46, s[24:27], s62 offen sc1
    s_waitcnt lgkmcnt(4)
    v_mfma_f32_32x32x16_bf16 v[96:111], v[196:199], a[44:47], v[96:111]
    ds_read_b64_tr_b16 v[192:193], v31 offset:7168
    ds_read_b64_tr_b16 v[194:195], v32 offset:7168
    v_fma_f32 v2, v39, v228, v230
    v_fma_f32 v3, v39, v229, v231
    v_fma_f32 v2, -v40, v229, v2
    s_waitcnt lgkmcnt(4)
    v_mfma_f32_32x32x16_bf16 v[96:111], v[200:203], a[48:51], v[96:111]
    ds_read_b64_tr_b16 v[196:197], v31 offset:7680
    ds_read_b64_tr_b16 v[198:199], v32 offset:7680
    v_fma_f32 v3, v40, v228, v3
    v_fma_f32 v4, v39, v2, v232
    v_fma_f32 v5, v39, v3, v233
    s_waitcnt lgkmcnt(4)
    v_mfma_f32_32x32x16_bf16 v[96:111], v[204:207], a[52:55], v[96:111]
    ds_read_b64_tr_b16 v[200:201], v31 offset:8192
    ds_read_b64_tr_b16 v[202:203], v32 offset:8192
    s_add_u32 s62, s3, 4096
    buffer_load_dwordx4 a[208:211], v45, s[24:27], s62 offen sc1
    buffer_load_dwordx4 a[212:215], v46, s[24:27], s62 offen sc1
    s_waitcnt lgkmcnt(4)
    v_mfma_f32_32x32x16_bf16 v[96:111], v[192:195], a[56:59], v[96:111]
    ds_read_b64_tr_b16 v[204:205], v31 offset:8704
    ds_read_b64_tr_b16 v[206:207], v32 offset:8704
    v_fma_f32 v4, -v40, v3, v4
    v_fma_f32 v5, v40, v2, v5
    v_fma_f32 v2, v39, v4, v234
    s_waitcnt lgkmcnt(4)
    v_mfma_f32_32x32x16_bf16 v[96:111], v[196:199], a[60:63], v[96:111]
    ds_read_b64_tr_b16 v[192:193], v31 offset:9216
    ds_read_b64_tr_b16 v[194:195], v32 offset:9216
    v_fma_f32 v3, v39, v5, v235
    v_fma_f32 v2, -v40, v5, v2
    v_fma_f32 v3, v40, v4, v3
    s_waitcnt lgkmcnt(4)
    v_mfma_f32_32x32x16_bf16 v[96:111], v[200:203], a[64:67], v[96:111]
    ds_read_b64_tr_b16 v[196:197], v31 offset:9728
    ds_read_b64_tr_b16 v[198:199], v32 offset:9728
    s_add_u32 s62, s3, 6144
    buffer_load_dwordx4 a[216:219], v45, s[24:27], s62 offen sc1
    buffer_load_dwordx4 a[220:223], v46, s[24:27], s62 offen sc1
    s_waitcnt lgkmcnt(4)
    v_mfma_f32_32x32x16_bf16 v[96:111], v[204:207], a[68:71], v[96:111]
    ds_read_b64_tr_b16 v[200:201], v31 offset:10240
    ds_read_b64_tr_b16 v[202:203], v32 offset:10240
    s_lshl_b32 s62, s50, 8
    v_lshl_add_u32 v27, v62, 3, s62
    ds_write_b64 v27, v[2:3] offset:16384
    s_waitcnt lgkmcnt(0)
    s_waitcnt vmcnt(18)
    s_barrier
    s_lshl_b32 s62, s49, 4
    s_add_u32 s62, s62, s48
    s_lshl_b32 s62, s62, 7
    s_add_u32 s62, s62, 16056320
    v_cmp_eq_u32 vcc, 0, v0
    v_mov_b32 v54, s100
    v_mov_b32 v55, s62
    v_cndmask_b32 v54, v54, v55, vcc
    v_mov_b32 v55, s101
    buffer_store_dword v55, v54, s[24:27], 0 offen sc1
    v_mfma_f32_32x32x16_bf16 v[96:111], v[192:195], a[72:75], v[96:111]
    ds_read_b64_tr_b16 v[204:205], v31 offset:10752
    ds_read_b64_tr_b16 v[206:207], v32 offset:10752
    v_mfma_f32_32x32x16_bf16 v[96:111], v[196:199], a[76:79], v[96:111]
    ds_read_b64_tr_b16 v[192:193], v31 offset:11264
    ds_read_b64_tr_b16 v[194:195], v32 offset:11264
    s_add_u32 s62, s3, 8192
    buffer_load_dwordx4 a[224:227], v45, s[24:27], s62 offen sc1
    buffer_load_dwordx4 a[228:231], v46, s[24:27], s62 offen sc1
    v_mfma_f32_32x32x16_bf16 v[96:111], v[200:203], a[80:83], v[96:111]
    ds_read_b64_tr_b16 v[196:197], v31 offset:11776
    ds_read_b64_tr_b16 v[198:199], v32 offset:11776
    v_lshlrev_b32 v27, 3, v62
    ds_read_b64 v[228:229], v27 offset:16384
    ds_read_b64 v[230:231], v27 offset:16640
    ds_read_b64 v[232:233], v27 offset:16896
    ds_read_b64 v[234:235], v27 offset:17152
    s_waitcnt lgkmcnt(8)
    v_mfma_f32_32x32x16_bf16 v[96:111], v[204:207], a[84:87], v[96:111]
    ds_read_b64_tr_b16 v[200:201], v31 offset:12288
    ds_read_b64_tr_b16 v[202:203], v32 offset:12288
    s_waitcnt lgkmcnt(2)
    v_fma_f32 v2, v58, v228, v230
    v_fma_f32 v3, v58, v229, v231
    v_mfma_f32_32x32x16_bf16 v[96:111], v[192:195], a[88:91], v[96:111]
    ds_read_b64_tr_b16 v[204:205], v31 offset:12800
    ds_read_b64_tr_b16 v[206:207], v32 offset:12800
    s_add_u32 s62, s3, 10240
    buffer_load_dwordx4 a[232:235], v45, s[24:27], s62 offen sc1
    buffer_load_dwordx4 a[236:239], v46, s[24:27], s62 offen sc1
    v_mfma_f32_32x32x16_bf16 v[96:111], v[196:199], a[92:95], v[96:111]
    ds_read_b64_tr_b16 v[192:193], v31 offset:13312
    ds_read_b64_tr_b16 v[194:195], v32 offset:13312
    v_fma_f32 v2, -v59, v229, v2
    v_fma_f32 v3, v59, v228, v3
    v_fma_f32 v4, v58, v2, v232
    s_waitcnt lgkmcnt(4)
    v_mfma_f32_32x32x16_bf16 v[96:111], v[200:203], a[96:99], v[96:111]
    ds_read_b64_tr_b16 v[196:197], v31 offset:13824
    ds_read_b64_tr_b16 v[198:199], v32 offset:13824
    v_fma_f32 v5, v58, v3, v233
    v_fma_f32 v4, -v59, v3, v4
    v_fma_f32 v5, v59, v2, v5
    s_waitcnt lgkmcnt(4)
    v_mfma_f32_32x32x16_bf16 v[96:111], v[204:207], a[100:103], v[96:111]
    ds_read_b64_tr_b16 v[200:201], v31 offset:14336
    ds_read_b64_tr_b16 v[202:203], v32 offset:14336
    s_add_u32 s62, s3, 12288
    buffer_load_dwordx4 a[240:243], v45, s[24:27], s62 offen sc1
    buffer_load_dwordx4 a[244:247], v46, s[24:27], s62 offen sc1
    s_waitcnt lgkmcnt(4)
    v_mfma_f32_32x32x16_bf16 v[96:111], v[192:195], a[104:107], v[96:111]
    ds_read_b64_tr_b16 v[204:205], v31 offset:14848
    ds_read_b64_tr_b16 v[206:207], v32 offset:14848
    v_fma_f32 v2, v58, v4, v234
    v_fma_f32 v3, v58, v5, v235
    v_fma_f32 v2, -v59, v5, v2
    s_waitcnt lgkmcnt(4)
    v_mfma_f32_32x32x16_bf16 v[96:111], v[196:199], a[108:111], v[96:111]
    ds_read_b64_tr_b16 v[192:193], v31 offset:15360
    ds_read_b64_tr_b16 v[194:195], v32 offset:15360
    v_fma_f32 v3, v59, v4, v3
    v_fma_f32 v6, v41, v2, v43
    v_fma_f32 v7, v41, v3, v44
    s_waitcnt lgkmcnt(4)
    v_mfma_f32_32x32x16_bf16 v[96:111], v[200:203], a[112:115], v[96:111]
    ds_read_b64_tr_b16 v[196:197], v31 offset:15872
    ds_read_b64_tr_b16 v[198:199], v32 offset:15872
    s_add_u32 s62, s3, 14336
    buffer_load_dwordx4 a[248:251], v45, s[24:27], s62 offen sc1
    buffer_load_dwordx4 a[252:255], v46, s[24:27], s62 offen sc1
    s_waitcnt lgkmcnt(4)
    v_mfma_f32_32x32x16_bf16 v[96:111], v[204:207], a[116:119], v[96:111]
    v_fma_f32 v6, -v42, v3, v6
    v_fma_f32 v7, v42, v2, v7
    v_mov_b32 v43, v6
    v_mov_b32 v44, v7
    s_waitcnt lgkmcnt(2)
    v_mfma_f32_32x32x16_bf16 v[96:111], v[192:195], a[120:123], v[96:111]
    s_waitcnt lgkmcnt(0)
    v_mfma_f32_32x32x16_bf16 v[96:111], v[196:199], a[124:127], v[96:111]
    s_add_u32 s62, s92, 4096
    buffer_load_dwordx4 a[0:3], v45, s[24:27], s62 offen sc1
    buffer_load_dwordx4 a[4:7], v46, s[24:27], s62 offen sc1
    v_fma_f32 v222, v33, v43, v64
    v_fma_f32 v223, v33, v44, v80
    v_fma_f32 v64, -v34, v44, v222
    v_fma_f32 v80, v34, v43, v223
    v_fma_f32 v222, v33, v64, v65
    v_fma_f32 v223, v33, v80, v81
    v_fma_f32 v65, -v34, v80, v222
    v_fma_f32 v81, v34, v64, v223
    v_fma_f32 v222, v33, v65, v66
    v_fma_f32 v223, v33, v81, v82
    s_add_u32 s63, s92, 6144
    buffer_load_dwordx4 a[8:11], v45, s[24:27], s63 offen sc1
    v_fma_f32 v66, -v34, v81, v222
    v_fma_f32 v82, v34, v65, v223
    v_fma_f32 v222, v33, v66, v67
    v_fma_f32 v223, v33, v82, v83
    v_fma_f32 v67, -v34, v82, v222
    v_fma_f32 v83, v34, v66, v223
    v_fma_f32 v222, v33, v67, v68
    v_fma_f32 v223, v33, v83, v84
    v_fma_f32 v68, -v34, v83, v222
    v_fma_f32 v84, v34, v67, v223
    s_add_u32 s63, s92, 6144
    buffer_load_dwordx4 a[12:15], v46, s[24:27], s63 offen sc1
    v_fma_f32 v222, v33, v68, v69
    v_fma_f32 v223, v33, v84, v85
    v_fma_f32 v69, -v34, v84, v222
    v_fma_f32 v85, v34, v68, v223
    v_fma_f32 v222, v33, v69, v70
    v_fma_f32 v223, v33, v85, v86
    v_fma_f32 v70, -v34, v85, v222
    v_fma_f32 v86, v34, v69, v223
    v_fma_f32 v222, v33, v70, v71
    v_fma_f32 v223, v33, v86, v87
    s_add_u32 s63, s92, 12288
    buffer_load_dwordx4 a[16:19], v45, s[24:27], s63 offen sc1
    v_fma_f32 v71, -v34, v86, v222
    v_fma_f32 v87, v34, v70, v223
    v_fma_f32 v222, v33, v71, v72
    v_fma_f32 v223, v33, v87, v88
    v_fma_f32 v72, -v34, v87, v222
    v_fma_f32 v88, v34, v71, v223
    v_fma_f32 v222, v33, v72, v73
    v_fma_f32 v223, v33, v88, v89
    v_fma_f32 v73, -v34, v88, v222
    v_fma_f32 v89, v34, v72, v223
    s_add_u32 s63, s92, 12288
    buffer_load_dwordx4 a[20:23], v46, s[24:27], s63 offen sc1
    v_fma_f32 v222, v33, v73, v74
    v_fma_f32 v223, v33, v89, v90
    v_fma_f32 v74, -v34, v89, v222
    v_fma_f32 v90, v34, v73, v223
    v_fma_f32 v222, v33, v74, v75
    v_fma_f32 v223, v33, v90, v91
    v_fma_f32 v75, -v34, v90, v222
    v_fma_f32 v91, v34, v74, v223
    v_fma_f32 v222, v33, v75, v76
    v_fma_f32 v223, v33, v91, v92
    s_add_u32 s63, s92, 14336
    buffer_load_dwordx4 a[24:27], v45, s[24:27], s63 offen sc1
    v_fma_f32 v76, -v34, v91, v222
    v_fma_f32 v92, v34, v75, v223
    v_fma_f32 v222, v33, v76, v77
    v_fma_f32 v223, v33, v92, v93
    v_fma_f32 v77, -v34, v92, v222
    v_fma_f32 v93, v34, v76, v223
    v_fma_f32 v222, v33, v77, v78
    v_fma_f32 v223, v33, v93, v94
    v_fma_f32 v78, -v34, v93, v222
    v_fma_f32 v94, v34, v77, v223
    s_add_u32 s63, s92, 14336
    buffer_load_dwordx4 a[28:31], v46, s[24:27], s63 offen sc1
    v_fma_f32 v222, v33, v78, v79
    v_fma_f32 v223, v33, v94, v95
    v_fma_f32 v79, -v34, v94, v222
    v_fma_f32 v95, v34, v78, v223
    v_pk_mul_f32 v[224:225], v[64:65], v[34:35] op_sel:[0,1] op_sel_hi:[1,1]
    v_pk_mul_f32 v[226:227], v[80:81], v[34:35] op_sel:[0,1] op_sel_hi:[1,1]
    v_pk_fma_f32 v[224:225], v[80:81], v[36:37], v[224:225] op_sel_hi:[1,0,1] neg_lo:[1,0,0] neg_hi:[1,0,0]
    v_pk_fma_f32 v[226:227], v[64:65], v[36:37], v[226:227] op_sel_hi:[1,0,1] neg_lo:[1,0,1] neg_hi:[1,0,1]
    v_xor_b32 v230, 0, v49
    v_cvt_pk_bf16_f32 v228, v224, v226
    s_add_u32 s63, s93, 36864
    buffer_load_dwordx4 a[32:35], v45, s[24:27], s63 offen sc1
    v_cvt_pk_bf16_f32 v229, v225, v227
    ds_write_b32 v230, v228 offset:0
    ds_write_b32 v230, v229 offset:128
    v_pk_mul_f32 v[224:225], v[66:67], v[34:35] op_sel:[0,1] op_sel_hi:[1,1]
    v_pk_mul_f32 v[226:227], v[82:83], v[34:35] op_sel:[0,1] op_sel_hi:[1,1]
    v_pk_fma_f32 v[224:225], v[82:83], v[36:37], v[224:225] op_sel_hi:[1,0,1] neg_lo:[1,0,0] neg_hi:[1,0,0]
    v_pk_fma_f32 v[226:227], v[66:67], v[36:37], v[226:227] op_sel_hi:[1,0,1] neg_lo:[1,0,1] neg_hi:[1,0,1]
    v_xor_b32 v230, 16, v49
    v_cvt_pk_bf16_f32 v228, v224, v226
    v_cvt_pk_bf16_f32 v229, v225, v227
    ds_write_b32 v230, v228 offset:256
    ds_write_b32 v230, v229 offset:384
    v_pk_mul_f32 v[224:225], v[68:69], v[34:35] op_sel:[0,1] op_sel_hi:[1,1]
    v_pk_mul_f32 v[226:227], v[84:85], v[34:35] op_sel:[0,1] op_sel_hi:[1,1]
    s_add_u32 s63, s93, 36864
    buffer_load_dwordx4 a[36:39], v46, s[24:27], s63 offen sc1
    v_pk_fma_f32 v[224:225], v[84:85], v[36:37], v[224:225] op_sel_hi:[1,0,1] neg_lo:[1,0,0] neg_hi:[1,0,0]
    v_pk_fma_f32 v[226:227], v[68:69], v[36:37], v[226:227] op_sel_hi:[1,0,1] neg_lo:[1,0,1] neg_hi:[1,0,1]
    v_xor_b32 v230, 32, v49
    v_cvt_pk_bf16_f32 v228, v224, v226
    v_cvt_pk_bf16_f32 v229, v225, v227
    ds_write_b32 v230, v228 offset:512
    ds_write_b32 v230, v229 offset:640
    v_pk_mul_f32 v[224:225], v[70:71], v[34:35] op_sel:[0,1] op_sel_hi:[1,1]
    v_pk_mul_f32 v[226:227], v[86:87], v[34:35] op_sel:[0,1] op_sel_hi:[1,1]
    v_pk_fma_f32 v[224:225], v[86:87], v[36:37], v[224:225] op_sel_hi:[1,0,1] neg_lo:[1,0,0] neg_hi:[1,0,0]
    v_pk_fma_f32 v[226:227], v[70:71], v[36:37], v[226:227] op_sel_hi:[1,0,1] neg_lo:[1,0,1] neg_hi:[1,0,1]
    v_xor_b32 v230, 48, v49
    s_add_u32 s63, s93, 38912
    buffer_load_dwordx4 a[40:43], v45, s[24:27], s63 offen sc1
    v_cvt_pk_bf16_f32 v228, v224, v226
    v_cvt_pk_bf16_f32 v229, v225, v227
    ds_write_b32 v230, v228 offset:768
    ds_write_b32 v230, v229 offset:896
    v_pk_mul_f32 v[224:225], v[72:73], v[34:35] op_sel:[0,1] op_sel_hi:[1,1]
    v_pk_mul_f32 v[226:227], v[88:89], v[34:35] op_sel:[0,1] op_sel_hi:[1,1]
    v_pk_fma_f32 v[224:225], v[88:89], v[36:37], v[224:225] op_sel_hi:[1,0,1] neg_lo:[1,0,0] neg_hi:[1,0,0]
    v_pk_fma_f32 v[226:227], v[72:73], v[36:37], v[226:227] op_sel_hi:[1,0,1] neg_lo:[1,0,1] neg_hi:[1,0,1]
    v_xor_b32 v230, 64, v49
    v_cvt_pk_bf16_f32 v228, v224, v226
    v_cvt_pk_bf16_f32 v229, v225, v227
    ds_write_b32 v230, v228 offset:1024
    ds_write_b32 v230, v229 offset:1152
    v_pk_mul_f32 v[224:225], v[74:75], v[34:35] op_sel:[0,1] op_sel_hi:[1,1]
    s_add_u32 s63, s93, 38912
    buffer_load_dwordx4 a[44:47], v46, s[24:27], s63 offen sc1
    v_pk_mul_f32 v[226:227], v[90:91], v[34:35] op_sel:[0,1] op_sel_hi:[1,1]
    v_pk_fma_f32 v[224:225], v[90:91], v[36:37], v[224:225] op_sel_hi:[1,0,1] neg_lo:[1,0,0] neg_hi:[1,0,0]
    v_pk_fma_f32 v[226:227], v[74:75], v[36:37], v[226:227] op_sel_hi:[1,0,1] neg_lo:[1,0,1] neg_hi:[1,0,1]
    v_xor_b32 v230, 80, v49
    v_cvt_pk_bf16_f32 v228, v224, v226
    v_cvt_pk_bf16_f32 v229, v225, v227
    ds_write_b32 v230, v228 offset:1280
    ds_write_b32 v230, v229 offset:1408
    v_pk_mul_f32 v[224:225], v[76:77], v[34:35] op_sel:[0,1] op_sel_hi:[1,1]
    v_pk_mul_f32 v[226:227], v[92:93], v[34:35] op_sel:[0,1] op_sel_hi:[1,1]
    v_pk_fma_f32 v[224:225], v[92:93], v[36:37], v[224:225] op_sel_hi:[1,0,1] neg_lo:[1,0,0] neg_hi:[1,0,0]
    v_pk_fma_f32 v[226:227], v[76:77], v[36:37], v[226:227] op_sel_hi:[1,0,1] neg_lo:[1,0,1] neg_hi:[1,0,1]
    v_xor_b32 v230, 96, v49
    v_cvt_pk_bf16_f32 v228, v224, v226
    v_cvt_pk_bf16_f32 v229, v225, v227
    ds_write_b32 v230, v228 offset:1536
    ds_write_b32 v230, v229 offset:1664
    v_pk_mul_f32 v[224:225], v[78:79], v[34:35] op_sel:[0,1] op_sel_hi:[1,1]
    v_pk_mul_f32 v[226:227], v[94:95], v[34:35] op_sel:[0,1] op_sel_hi:[1,1]
    v_pk_fma_f32 v[224:225], v[94:95], v[36:37], v[224:225] op_sel_hi:[1,0,1] neg_lo:[1,0,0] neg_hi:[1,0,0]
    v_pk_fma_f32 v[226:227], v[78:79], v[36:37], v[226:227] op_sel_hi:[1,0,1] neg_lo:[1,0,1] neg_hi:[1,0,1]
    v_xor_b32 v230, 112, v49
    v_cvt_pk_bf16_f32 v228, v224, v226
    v_cvt_pk_bf16_f32 v229, v225, v227
    ds_write_b32 v230, v228 offset:1792
    ds_write_b32 v230, v229 offset:1920
    s_lshl_b32 s62, s83, 2
    s_add_u32 s62, s62, s50
    s_lshl_b32 s62, s62, 1
    v_add_u32 v20, s62, v1
    v_lshl_add_u32 v20, v20, 4, s81
    v_lshlrev_b32 v20, 7, v20
    v_add_u32 v20, 16056320, v20
    v_cmp_gt_u32 vcc, 2, v1
    v_mov_b32 v21, s100
    s_nop 0
    v_cndmask_b32 v20, v21, v20, vcc
    buffer_load_dword v22, v20, s[24:27], 0 offen sc1
    v_pk_mul_f32 v[232:233], v[160:161], v[160:161]
    v_pk_fma_f32 v[232:233], v[232:233], v[56:57], v[56:57] op_sel:[0,1,0] op_sel_hi:[1,1,0]
    v_pk_mul_f32 v[232:233], v[160:161], v[232:233]
    v_exp_f32 v232, v232
    v_exp_f32 v233, v233
    v_pk_mul_f32 v[234:235], v[160:161], v[168:169]
    v_pk_add_f32 v[232:233], v[232:233], 1.0 op_sel_hi:[1,0]
    v_rcp_f32 v232, v232
    v_rcp_f32 v233, v233
    v_pk_mul_f32 v[236:237], v[162:163], v[162:163]
    v_pk_mul_f32 v[234:235], v[234:235], v[232:233]
    v_cvt_pk_bf16_f32 v208, v234, v235
    v_pk_fma_f32 v[236:237], v[236:237], v[56:57], v[56:57] op_sel:[0,1,0] op_sel_hi:[1,1,0]
    v_pk_mul_f32 v[236:237], v[162:163], v[236:237]
    v_exp_f32 v236, v236
    v_exp_f32 v237, v237
    v_pk_mul_f32 v[238:239], v[162:163], v[170:171]
    v_pk_add_f32 v[236:237], v[236:237], 1.0 op_sel_hi:[1,0]
    v_rcp_f32 v236, v236
    v_rcp_f32 v237, v237
    v_pk_mul_f32 v[232:233], v[164:165], v[164:165]
    v_pk_mul_f32 v[238:239], v[238:239], v[236:237]
    v_cvt_pk_bf16_f32 v209, v238, v239
    v_pk_fma_f32 v[232:233], v[232:233], v[56:57], v[56:57] op_sel:[0,1,0] op_sel_hi:[1,1,0]
    v_pk_mul_f32 v[232:233], v[164:165], v[232:233]
    v_exp_f32 v232, v232
    v_exp_f32 v233, v233
    v_pk_mul_f32 v[234:235], v[164:165], v[172:173]
    v_pk_add_f32 v[232:233], v[232:233], 1.0 op_sel_hi:[1,0]
    v_rcp_f32 v232, v232
    v_rcp_f32 v233, v233
    v_pk_mul_f32 v[236:237], v[166:167], v[166:167]
    v_pk_mul_f32 v[234:235], v[234:235], v[232:233]
    v_cvt_pk_bf16_f32 v210, v234, v235
    v_pk_fma_f32 v[236:237], v[236:237], v[56:57], v[56:57] op_sel:[0,1,0] op_sel_hi:[1,1,0]
    v_pk_mul_f32 v[236:237], v[166:167], v[236:237]
    v_exp_f32 v236, v236
    v_exp_f32 v237, v237
    v_pk_mul_f32 v[238:239], v[166:167], v[174:175]
    v_pk_add_f32 v[236:237], v[236:237], 1.0 op_sel_hi:[1,0]
    v_rcp_f32 v236, v236
    v_rcp_f32 v237, v237
    s_nop 0
    v_pk_mul_f32 v[238:239], v[238:239], v[236:237]
    v_cvt_pk_bf16_f32 v211, v238, v239
    s_add_u32 s62, s94, 4096
    buffer_store_dwordx4 v[208:211], v60, s[24:27], s62 offen sc1
    s_waitcnt lgkmcnt(0)
    v_xor_b32 v230, 0, v50
    ds_read_b128 v[240:243], v230
    v_xor_b32 v230, 32, v50
    ds_read_b128 v[244:247], v230
    v_xor_b32 v230, 64, v50
    ds_read_b128 v[248:251], v230
    v_xor_b32 v230, 96, v50
    ds_read_b128 v[252:255], v230
    v_pk_mul_f32 v[232:233], v[176:177], v[176:177]
    v_pk_fma_f32 v[232:233], v[232:233], v[56:57], v[56:57] op_sel:[0,1,0] op_sel_hi:[1,1,0]
    v_pk_mul_f32 v[232:233], v[176:177], v[232:233]
    v_exp_f32 v232, v232
    v_exp_f32 v233, v233
    v_pk_mul_f32 v[234:235], v[176:177], v[184:185]
    v_pk_add_f32 v[232:233], v[232:233], 1.0 op_sel_hi:[1,0]
    v_rcp_f32 v232, v232
    v_rcp_f32 v233, v233
    v_pk_mul_f32 v[236:237], v[178:179], v[178:179]
    v_pk_mul_f32 v[234:235], v[234:235], v[232:233]
    v_cvt_pk_bf16_f32 v212, v234, v235
    v_pk_fma_f32 v[236:237], v[236:237], v[56:57], v[56:57] op_sel:[0,1,0] op_sel_hi:[1,1,0]
    v_pk_mul_f32 v[236:237], v[178:179], v[236:237]
    v_exp_f32 v236, v236
    v_exp_f32 v237, v237
    v_pk_mul_f32 v[238:239], v[178:179], v[186:187]
    v_pk_add_f32 v[236:237], v[236:237], 1.0 op_sel_hi:[1,0]
    v_rcp_f32 v236, v236
    v_rcp_f32 v237, v237
    v_pk_mul_f32 v[232:233], v[180:181], v[180:181]
    v_pk_mul_f32 v[238:239], v[238:239], v[236:237]
    v_cvt_pk_bf16_f32 v213, v238, v239
    v_pk_fma_f32 v[232:233], v[232:233], v[56:57], v[56:57] op_sel:[0,1,0] op_sel_hi:[1,1,0]
    v_pk_mul_f32 v[232:233], v[180:181], v[232:233]
    v_exp_f32 v232, v232
    v_exp_f32 v233, v233
    v_pk_mul_f32 v[234:235], v[180:181], v[188:189]
    v_pk_add_f32 v[232:233], v[232:233], 1.0 op_sel_hi:[1,0]
    v_rcp_f32 v232, v232
    v_rcp_f32 v233, v233
    v_pk_mul_f32 v[236:237], v[182:183], v[182:183]
    v_pk_mul_f32 v[234:235], v[234:235], v[232:233]
    v_cvt_pk_bf16_f32 v214, v234, v235
    v_pk_fma_f32 v[236:237], v[236:237], v[56:57], v[56:57] op_sel:[0,1,0] op_sel_hi:[1,1,0]
    v_pk_mul_f32 v[236:237], v[182:183], v[236:237]
    v_exp_f32 v236, v236
    v_exp_f32 v237, v237
    v_pk_mul_f32 v[238:239], v[182:183], v[190:191]
    v_pk_add_f32 v[236:237], v[236:237], 1.0 op_sel_hi:[1,0]
    v_rcp_f32 v236, v236
    v_rcp_f32 v237, v237
    s_nop 0
    v_pk_mul_f32 v[238:239], v[238:239], v[236:237]
    v_cvt_pk_bf16_f32 v215, v238, v239
    s_add_u32 s62, s95, 4096
    buffer_store_dwordx4 v[212:215], v60, s[24:27], s62 offen sc1
    s_waitcnt lgkmcnt(3)
    s_add_u32 s62, s87, 0
    buffer_store_dwordx4 v[240:243], v60, s[24:27], s62 offen sc1
    s_waitcnt lgkmcnt(2)
    s_add_u32 s62, s87, 2048
    buffer_store_dwordx4 v[244:247], v60, s[24:27], s62 offen sc1
    s_waitcnt lgkmcnt(1)
    s_add_u32 s62, s87, 4096
    buffer_store_dwordx4 v[248:251], v60, s[24:27], s62 offen sc1
    s_waitcnt lgkmcnt(0)
    s_add_u32 s62, s87, 6144
    buffer_store_dwordx4 v[252:255], v60, s[24:27], s62 offen sc1
    v_pk_mul_f32 v[232:233], v[96:97], v[96:97]
    v_pk_fma_f32 v[232:233], v[232:233], v[56:57], v[56:57] op_sel:[0,1,0] op_sel_hi:[1,1,0]
    v_pk_mul_f32 v[232:233], v[96:97], v[232:233]
    v_exp_f32 v232, v232
    v_exp_f32 v233, v233
    v_pk_mul_f32 v[234:235], v[96:97], v[104:105]
    v_pk_add_f32 v[232:233], v[232:233], 1.0 op_sel_hi:[1,0]
    v_rcp_f32 v232, v232
    v_rcp_f32 v233, v233
    v_pk_mul_f32 v[236:237], v[98:99], v[98:99]
    v_pk_mul_f32 v[234:235], v[234:235], v[232:233]
    v_cvt_pk_bf16_f32 v208, v234, v235
    v_pk_fma_f32 v[236:237], v[236:237], v[56:57], v[56:57] op_sel:[0,1,0] op_sel_hi:[1,1,0]
    v_pk_mul_f32 v[236:237], v[98:99], v[236:237]
    v_exp_f32 v236, v236
    v_exp_f32 v237, v237
    v_pk_mul_f32 v[238:239], v[98:99], v[106:107]
    v_pk_add_f32 v[236:237], v[236:237], 1.0 op_sel_hi:[1,0]
    v_rcp_f32 v236, v236
    v_rcp_f32 v237, v237
    v_pk_mul_f32 v[232:233], v[100:101], v[100:101]
    v_pk_mul_f32 v[238:239], v[238:239], v[236:237]
    v_cvt_pk_bf16_f32 v209, v238, v239
    v_pk_fma_f32 v[232:233], v[232:233], v[56:57], v[56:57] op_sel:[0,1,0] op_sel_hi:[1,1,0]
    v_pk_mul_f32 v[232:233], v[100:101], v[232:233]
    v_exp_f32 v232, v232
    v_exp_f32 v233, v233
    v_pk_mul_f32 v[234:235], v[100:101], v[108:109]
    v_pk_add_f32 v[232:233], v[232:233], 1.0 op_sel_hi:[1,0]
    v_rcp_f32 v232, v232
    v_rcp_f32 v233, v233
    v_pk_mul_f32 v[236:237], v[102:103], v[102:103]
    v_pk_mul_f32 v[234:235], v[234:235], v[232:233]
    v_cvt_pk_bf16_f32 v210, v234, v235
    v_pk_fma_f32 v[236:237], v[236:237], v[56:57], v[56:57] op_sel:[0,1,0] op_sel_hi:[1,1,0]
    v_pk_mul_f32 v[236:237], v[102:103], v[236:237]
    v_exp_f32 v236, v236
    v_exp_f32 v237, v237
    v_pk_mul_f32 v[238:239], v[102:103], v[110:111]
    v_pk_add_f32 v[236:237], v[236:237], 1.0 op_sel_hi:[1,0]
    v_rcp_f32 v236, v236
    v_rcp_f32 v237, v237
    s_nop 0
    v_pk_mul_f32 v[238:239], v[238:239], v[236:237]
    v_cvt_pk_bf16_f32 v211, v238, v239
    s_add_u32 s62, s86, 0
    buffer_store_dwordx4 v[208:211], v60, s[24:27], s62 offen sc1
    s_lshl_b32 s62, s81, 1
    s_add_u32 s62, s62, 1
    s_sub_u32 s62, s62, s83
    s_sub_u32 s62, s62, s82
    s_mul_i32 s62, s62, 360448
    s_sub_u32 s62, s62, 12582912
    s_add_u32 s53, s3, s62
    s_add_u32 s54, s92, s62
    s_add_u32 s55, s93, s62
    s_lshl_b32 s56, s83, 1
    s_sub_u32 s56, s56, 1
    s_mul_i32 s56, s56, 360448
    s_lshl_b32 s62, s52, 10
    v_add_u32 v11, s62, v60
    v_xor_b32 v5, 0x400, v11
    s_waitcnt vmcnt(7)
gated_mix__ssm_conv_s5__glu_gated_geglu__prompt_kernel_chk_h2:
    v_cmp_eq_u32 vcc, s101, v22
    s_and_b32 s60, vcc_lo, 0x3
    s_cmp_eq_u32 s60, 0x3
    s_cbranch_scc0 gated_mix__ssm_conv_s5__glu_gated_geglu__prompt_kernel_spin_h2
gated_mix__ssm_conv_s5__glu_gated_geglu__prompt_kernel_ok_h2:
    s_add_u32 s62, s54, 0
    buffer_load_dwordx4 a[48:51], v11, s[24:27], s62 offen sc1
    buffer_load_dwordx4 a[52:55], v5, s[24:27], s62 offen sc1
    s_add_u32 s62, s54, 2048
    buffer_load_dwordx4 a[56:59], v11, s[24:27], s62 offen sc1
    buffer_load_dwordx4 a[60:63], v5, s[24:27], s62 offen sc1
    s_add_u32 s62, s54, 8192
    buffer_load_dwordx4 a[64:67], v11, s[24:27], s62 offen sc1
    buffer_load_dwordx4 a[68:71], v5, s[24:27], s62 offen sc1
    s_add_u32 s62, s54, 10240
    buffer_load_dwordx4 a[72:75], v11, s[24:27], s62 offen sc1
    buffer_load_dwordx4 a[76:79], v5, s[24:27], s62 offen sc1
    s_lshl_b32 s62, s83, 2
    s_add_u32 s62, s62, s50
    s_lshl_b32 s62, s62, 1
    v_add_u32 v8, s62, v1
    v_lshl_add_u32 v8, v8, 4, s81
    v_lshlrev_b32 v8, 7, v8
    v_add_u32 v8, 16023552, v8
    v_cmp_gt_u32 vcc, 2, v1
    v_mov_b32 v9, s100
    s_nop 0
    v_cndmask_b32 v8, v9, v8, vcc
    v_lshl_add_u32 v6, v1, 4, s81
    v_lshlrev_b32 v6, 7, v6
    v_add_u32 v6, 15990784, v6
    v_cmp_gt_u32 vcc, 16, v1
    v_mov_b32 v7, s100
    s_nop 0
    v_cndmask_b32 v6, v7, v6, vcc
    buffer_load_dword v7, v6, s[24:27], 0 offen sc1
    s_mov_b32 s90, 4194304
    s_mov_b32 s91, 0x20000
    s_lshl_b32 s62, s81, 2
    s_lshl_b32 s63, s83, 1
    s_add_u32 s62, s62, s63
    s_add_u32 s62, s62, s52
    s_lshl_b32 s62, s62, 14
    s_lshl_b32 s63, s82, 1
    s_add_u32 s63, s63, s51
    s_lshl_b32 s63, s63, 5
    s_add_u32 s62, s62, s63
    v_lshlrev_b32 v2, 13, v61
    v_add_u32 v2, v2, v62
    v_lshlrev_b32 v3, 1, v2
    v_lshlrev_b32 v4, 2, v2
    s_cmp_ge_u32 s50, 2
    s_cselect_b64 s[64:65], -1, 0
    s_lshl_b32 s94, s62, 1
    s_lshl_b32 s95, s62, 2
    v_add_u32 v9, s63, v62
    v_lshlrev_b32 v9, 1, v9
    v_mov_b32 v10, 0
    global_load_short_d16_hi v10, v9, s[42:43]
    v_mov_b32 v44, 0
    v_mov_b32 v45, 0
    v_mov_b32 v46, 0
    v_mov_b32 v47, 0
    v_mov_b32 v48, 0
    v_mov_b32 v49, 0
    v_mov_b32 v50, 0
    v_mov_b32 v51, 0
    v_mov_b32 v52, 0
    v_mov_b32 v53, 0
    v_mov_b32 v54, 0
    v_mov_b32 v55, 0
    v_mov_b32 v56, 0
    v_mov_b32 v57, 0
    v_mov_b32 v58, 0
    v_mov_b32 v59, 0
    s_lshl_b32 s62, s81, 3
    s_add_u32 s62, s62, s82
    s_lshl_b32 s62, s62, 3
    s_add_u32 s62, s62, s50
    s_lshl_b32 s63, s83, 2
    s_add_u32 s58, s62, s63
    s_xor_b32 s63, s63, 4
    s_add_u32 s57, s62, s63
    s_waitcnt vmcnt(10)
    s_barrier
    s_lshl_b32 s62, s49, 4
    s_add_u32 s62, s62, s48
    s_lshl_b32 s62, s62, 7
    s_add_u32 s62, s62, 16023552
    v_cmp_eq_u32 vcc, 0, v0
    v_mov_b32 v54, s100
    v_mov_b32 v55, s62
    v_cndmask_b32 v54, v54, v55, vcc
    v_mov_b32 v55, s101
    buffer_store_dword v55, v54, s[24:27], 0 offen sc1
    s_nop 1
    v_mov_b32 v54, 0
    v_mov_b32 v55, 0
    s_waitcnt vmcnt(9)
    v_mfma_f32_32x32x16_bf16 v[64:79], a[48:51], a[128:131], 0
    v_mfma_f32_32x32x16_bf16 v[80:95], a[48:51], a[132:135], 0
    s_add_u32 s62, s55, 32768
    buffer_load_dwordx4 a[80:83], v11, s[24:27], s62 offen sc1
    buffer_load_dwordx4 a[84:87], v5, s[24:27], s62 offen sc1
    v_mfma_f32_32x32x16_bf16 v[96:111], a[52:55], a[128:131], 0
    v_mfma_f32_32x32x16_bf16 v[112:127], a[52:55], a[132:135], 0
    s_add_u32 s62, s55, 34816
    buffer_load_dwordx4 a[88:91], v11, s[24:27], s62 offen sc1
    buffer_load_dwordx4 a[92:95], v5, s[24:27], s62 offen sc1
    s_waitcnt vmcnt(11)
    v_mfma_f32_32x32x16_bf16 v[64:79], a[56:59], a[136:139], v[64:79]
    v_mfma_f32_32x32x16_bf16 v[80:95], a[56:59], a[140:143], v[80:95]
    s_add_u32 s62, s55, 40960
    buffer_load_dwordx4 a[96:99], v11, s[24:27], s62 offen sc1
    buffer_load_dwordx4 a[100:103], v5, s[24:27], s62 offen sc1
    v_mfma_f32_32x32x16_bf16 v[96:111], a[60:63], a[136:139], v[96:111]
    v_mfma_f32_32x32x16_bf16 v[112:127], a[60:63], a[140:143], v[112:127]
    s_add_u32 s62, s55, 43008
    buffer_load_dwordx4 a[104:107], v11, s[24:27], s62 offen sc1
    buffer_load_dwordx4 a[108:111], v5, s[24:27], s62 offen sc1
    s_waitcnt vmcnt(13)
    v_mfma_f32_32x32x16_bf16 v[64:79], a[64:67], a[144:147], v[64:79]
    v_mfma_f32_32x32x16_bf16 v[80:95], a[64:67], a[148:151], v[80:95]
    s_add_u32 s62, s54, s56
    s_add_u32 s62, s62, 0
    buffer_load_dwordx4 a[48:51], v11, s[24:27], s62 offen sc1
    buffer_load_dwordx4 a[52:55], v5, s[24:27], s62 offen sc1
    v_mfma_f32_32x32x16_bf16 v[96:111], a[68:71], a[144:147], v[96:111]
    v_mfma_f32_32x32x16_bf16 v[112:127], a[68:71], a[148:151], v[112:127]
    s_add_u32 s62, s54, s56
    s_add_u32 s62, s62, 2048
    buffer_load_dwordx4 a[56:59], v11, s[24:27], s62 offen sc1
    buffer_load_dwordx4 a[60:63], v5, s[24:27], s62 offen sc1
    s_waitcnt vmcnt(15)
    v_mfma_f32_32x32x16_bf16 v[64:79], a[72:75], a[152:155], v[64:79]
    v_mfma_f32_32x32x16_bf16 v[80:95], a[72:75], a[156:159], v[80:95]
    s_add_u32 s62, s54, s56
    s_add_u32 s62, s62, 8192
    buffer_load_dwordx4 a[64:67], v11, s[24:27], s62 offen sc1
    buffer_load_dwordx4 a[68:71], v5, s[24:27], s62 offen sc1
    v_mfma_f32_32x32x16_bf16 v[96:111], a[76:79], a[152:155], v[96:111]
    v_mfma_f32_32x32x16_bf16 v[112:127], a[76:79], a[156:159], v[112:127]
    s_add_u32 s62, s54, s56
    s_add_u32 s62, s62, 10240
    buffer_load_dwordx4 a[72:75], v11, s[24:27], s62 offen sc1
    buffer_load_dwordx4 a[76:79], v5, s[24:27], s62 offen sc1
    buffer_load_dword v9, v8, s[24:27], 0 offen sc1
    s_waitcnt vmcnt(15)
    v_mfma_f32_32x32x16_bf16 v[64:79], a[80:83], a[160:163], v[64:79]
    v_mfma_f32_32x32x16_bf16 v[80:95], a[80:83], a[164:167], v[80:95]
gated_mix__ssm_conv_s5__glu_gated_geglu__prompt_kernel_chk_g:
    v_cmp_eq_u32 vcc, s101, v7
    s_and_b32 s60, vcc_lo, 0xffff
    s_cmp_eq_u32 s60, 0xffff
    s_cbranch_scc0 gated_mix__ssm_conv_s5__glu_gated_geglu__prompt_kernel_spin_g
gated_mix__ssm_conv_s5__glu_gated_geglu__prompt_kernel_ok_g:
    s_lshl_b32 s63, s81, 1
    s_add_u32 s63, s63, s83
    s_xor_b32 s63, s63, 1
    s_lshl_b32 s63, s63, 8
    s_add_u32 s63, s63, 15728640
    s_xor_b32 s62, s52, 0
    s_lshl_b32 s62, s62, 7
    v_lshlrev_b32 v7, 6, v61
    v_add_u32 v7, s62, v7
    buffer_load_dwordx4 v[12:15], v7, s[24:27], s63 offen offset:0 sc1
    buffer_load_dwordx4 v[16:19], v7, s[24:27], s63 offen offset:16 sc1
    buffer_load_dwordx4 v[20:23], v7, s[24:27], s63 offen offset:32 sc1
    buffer_load_dwordx4 v[24:27], v7, s[24:27], s63 offen offset:48 sc1
    s_xor_b32 s62, s52, 1
    s_lshl_b32 s62, s62, 7
    v_lshlrev_b32 v7, 6, v61
    v_add_u32 v7, s62, v7
    buffer_load_dwordx4 v[28:31], v7, s[24:27], s63 offen offset:0 sc1
    buffer_load_dwordx4 v[32:35], v7, s[24:27], s63 offen offset:16 sc1
    buffer_load_dwordx4 v[36:39], v7, s[24:27], s63 offen offset:32 sc1
    buffer_load_dwordx4 v[40:43], v7, s[24:27], s63 offen offset:48 sc1
    v_mfma_f32_32x32x16_bf16 v[96:111], a[84:87], a[160:163], v[96:111]
    v_mfma_f32_32x32x16_bf16 v[112:127], a[84:87], a[164:167], v[112:127]
    buffer_load_short_d16_hi v44, v3, s[4:7], s94 offen offset:0
    buffer_load_short_d16_hi v45, v3, s[4:7], s94 offen offset:1024
    s_waitcnt vmcnt(23)
    v_mfma_f32_32x32x16_bf16 v[64:79], a[88:91], a[168:171], v[64:79]
    v_mfma_f32_32x32x16_bf16 v[80:95], a[88:91], a[172:175], v[80:95]
    buffer_load_short_d16_hi v46, v3, s[4:7], s94 offen offset:2048
    buffer_load_short_d16_hi v47, v3, s[4:7], s94 offen offset:3072
    v_mfma_f32_32x32x16_bf16 v[96:111], a[92:95], a[168:171], v[96:111]
    v_mfma_f32_32x32x16_bf16 v[112:127], a[92:95], a[172:175], v[112:127]
    s_add_u32 s94, s94, 4096
    buffer_load_short_d16_hi v48, v3, s[4:7], s94 offen offset:0
    buffer_load_short_d16_hi v49, v3, s[4:7], s94 offen offset:1024
    s_waitcnt vmcnt(25)
    v_mfma_f32_32x32x16_bf16 v[64:79], a[96:99], a[176:179], v[64:79]
    v_mfma_f32_32x32x16_bf16 v[80:95], a[96:99], a[180:183], v[80:95]
    buffer_load_short_d16_hi v50, v3, s[4:7], s94 offen offset:2048
    buffer_load_short_d16_hi v51, v3, s[4:7], s94 offen offset:3072
    v_mfma_f32_32x32x16_bf16 v[96:111], a[100:103], a[176:179], v[96:111]
    v_mfma_f32_32x32x16_bf16 v[112:127], a[100:103], a[180:183], v[112:127]
    s_add_u32 s94, s94, 4096
    buffer_load_short_d16_hi v52, v3, s[4:7], s94 offen offset:0
    buffer_load_short_d16_hi v53, v3, s[4:7], s94 offen offset:1024
    s_waitcnt vmcnt(18)
gated_mix__ssm_conv_s5__glu_gated_geglu__prompt_kernel_chk_h:
    v_cmp_eq_u32 vcc, s101, v9
    s_and_b32 s60, vcc_lo, 0x3
    s_cmp_eq_u32 s60, 0x3
    s_cbranch_scc0 gated_mix__ssm_conv_s5__glu_gated_geglu__prompt_kernel_spin_h
gated_mix__ssm_conv_s5__glu_gated_geglu__prompt_kernel_ok_h:
    v_mfma_f32_32x32x16_bf16 v[64:79], a[104:107], a[184:187], v[64:79]
    v_mfma_f32_32x32x16_bf16 v[80:95], a[104:107], a[188:191], v[80:95]
    s_add_u32 s62, s53, 0
    buffer_load_dwordx4 a[80:83], v11, s[24:27], s62 offen sc1
    buffer_load_dwordx4 a[84:87], v5, s[24:27], s62 offen sc1
    v_mfma_f32_32x32x16_bf16 v[96:111], a[108:111], a[184:187], v[96:111]
    v_mfma_f32_32x32x16_bf16 v[112:127], a[108:111], a[188:191], v[112:127]
    s_add_u32 s62, s53, 2048
    buffer_load_dwordx4 a[88:91], v11, s[24:27], s62 offen sc1
    buffer_load_dwordx4 a[92:95], v5, s[24:27], s62 offen sc1
    v_mfma_f32_32x32x16_bf16 v[128:143], a[48:51], a[128:131], 0
    v_mfma_f32_32x32x16_bf16 v[144:159], a[48:51], a[132:135], 0
    buffer_load_short_d16_hi v54, v3, s[4:7], s94 offen offset:2048
    buffer_load_short_d16_hi v55, v3, s[4:7], s94 offen offset:3072
    v_mfma_f32_32x32x16_bf16 v[160:175], a[52:55], a[128:131], 0
    v_mfma_f32_32x32x16_bf16 v[176:191], a[52:55], a[132:135], 0
    s_add_u32 s94, s94, 4096
    buffer_load_short_d16_hi v56, v3, s[4:7], s94 offen offset:0
    buffer_load_short_d16_hi v57, v3, s[4:7], s94 offen offset:1024
    v_mfma_f32_32x32x16_bf16 v[128:143], a[56:59], a[136:139], v[128:143]
    v_mfma_f32_32x32x16_bf16 v[144:159], a[56:59], a[140:143], v[144:159]
    buffer_load_short_d16_hi v58, v3, s[4:7], s94 offen offset:2048
    buffer_load_short_d16_hi v59, v3, s[4:7], s94 offen offset:3072
    v_mfma_f32_32x32x16_bf16 v[160:175], a[60:63], a[136:139], v[160:175]
    v_mfma_f32_32x32x16_bf16 v[176:191], a[60:63], a[140:143], v[176:191]
    s_add_u32 s62, s53, 4096
    buffer_load_dwordx4 a[96:99], v11, s[24:27], s62 offen sc1
    buffer_load_dwordx4 a[100:103], v5, s[24:27], s62 offen sc1
    v_mfma_f32_32x32x16_bf16 v[128:143], a[64:67], a[144:147], v[128:143]
    v_mfma_f32_32x32x16_bf16 v[144:159], a[64:67], a[148:151], v[144:159]
    s_add_u32 s62, s53, 6144
    buffer_load_dwordx4 a[104:107], v11, s[24:27], s62 offen sc1
    buffer_load_dwordx4 a[108:111], v5, s[24:27], s62 offen sc1
    v_mfma_f32_32x32x16_bf16 v[160:175], a[68:71], a[144:147], v[160:175]
    v_mfma_f32_32x32x16_bf16 v[176:191], a[68:71], a[148:151], v[176:191]
    s_add_u32 s62, s53, 8192
    buffer_load_dwordx4 a[48:51], v11, s[24:27], s62 offen sc1
    buffer_load_dwordx4 a[52:55], v5, s[24:27], s62 offen sc1
    v_mfma_f32_32x32x16_bf16 v[128:143], a[72:75], a[152:155], v[128:143]
    v_mfma_f32_32x32x16_bf16 v[144:159], a[72:75], a[156:159], v[144:159]
    s_add_u32 s62, s53, 10240
    buffer_load_dwordx4 a[56:59], v11, s[24:27], s62 offen sc1
    buffer_load_dwordx4 a[60:63], v5, s[24:27], s62 offen sc1
    v_mfma_f32_32x32x16_bf16 v[160:175], a[76:79], a[152:155], v[160:175]
    v_mfma_f32_32x32x16_bf16 v[176:191], a[76:79], a[156:159], v[176:191]
    s_add_u32 s62, s53, 12288
    buffer_load_dwordx4 a[64:67], v11, s[24:27], s62 offen sc1
    buffer_load_dwordx4 a[68:71], v5, s[24:27], s62 offen sc1
    s_waitcnt vmcnt(18)
    v_mfma_f32_32x32x16_bf16 v[192:207], a[80:83], a[192:195], 0
    v_mfma_f32_32x32x16_bf16 v[208:223], a[80:83], a[196:199], 0
    s_add_u32 s62, s53, 14336
    buffer_load_dwordx4 a[72:75], v11, s[24:27], s62 offen sc1
    buffer_load_dwordx4 a[76:79], v5, s[24:27], s62 offen sc1
    v_mfma_f32_32x32x16_bf16 v[224:239], a[84:87], a[192:195], 0
    v_mfma_f32_32x32x16_bf16 v[240:255], a[84:87], a[196:199], 0
    s_add_u32 s62, s54, 4096
    buffer_load_dwordx4 a[80:83], v11, s[24:27], s62 offen sc1
    buffer_load_dwordx4 a[84:87], v5, s[24:27], s62 offen sc1
    s_waitcnt vmcnt(20)
    v_mfma_f32_32x32x16_bf16 v[192:207], a[88:91], a[200:203], v[192:207]
    v_mfma_f32_32x32x16_bf16 v[208:223], a[88:91], a[204:207], v[208:223]
    v_mfma_f32_32x32x16_bf16 v[224:239], a[92:95], a[200:203], v[224:239]
    v_mfma_f32_32x32x16_bf16 v[240:255], a[92:95], a[204:207], v[240:255]
    s_add_u32 s62, s54, 6144
    buffer_load_dwordx4 a[88:91], v11, s[24:27], s62 offen sc1
    buffer_load_dwordx4 a[92:95], v5, s[24:27], s62 offen sc1
    s_waitcnt vmcnt(14)
    v_mfma_f32_32x32x16_bf16 v[192:207], a[96:99], a[208:211], v[192:207]
    v_mfma_f32_32x32x16_bf16 v[208:223], a[96:99], a[212:215], v[208:223]
    v_mfma_f32_32x32x16_bf16 v[224:239], a[100:103], a[208:211], v[224:239]
    v_mfma_f32_32x32x16_bf16 v[240:255], a[100:103], a[212:215], v[240:255]
    s_add_u32 s62, s54, 12288
    buffer_load_dwordx4 a[96:99], v11, s[24:27], s62 offen sc1
    buffer_load_dwordx4 a[100:103], v5, s[24:27], s62 offen sc1
    s_waitcnt vmcnt(14)
    v_mfma_f32_32x32x16_bf16 v[192:207], a[104:107], a[216:219], v[192:207]
    v_mfma_f32_32x32x16_bf16 v[208:223], a[104:107], a[220:223], v[208:223]
    v_mfma_f32_32x32x16_bf16 v[224:239], a[108:111], a[216:219], v[224:239]
    v_mfma_f32_32x32x16_bf16 v[240:255], a[108:111], a[220:223], v[240:255]
    s_add_u32 s62, s54, 14336
    buffer_load_dwordx4 a[104:107], v11, s[24:27], s62 offen sc1
    buffer_load_dwordx4 a[108:111], v5, s[24:27], s62 offen sc1
    s_waitcnt vmcnt(14)
    v_mfma_f32_32x32x16_bf16 v[192:207], a[48:51], a[224:227], v[192:207]
    v_mfma_f32_32x32x16_bf16 v[208:223], a[48:51], a[228:231], v[208:223]
    v_mfma_f32_32x32x16_bf16 v[224:239], a[52:55], a[224:227], v[224:239]
    v_mfma_f32_32x32x16_bf16 v[240:255], a[52:55], a[228:231], v[240:255]
    s_add_u32 s62, s55, 36864
    buffer_load_dwordx4 a[48:51], v11, s[24:27], s62 offen sc1
    buffer_load_dwordx4 a[52:55], v5, s[24:27], s62 offen sc1
    s_waitcnt vmcnt(14)
    v_mfma_f32_32x32x16_bf16 v[192:207], a[56:59], a[232:235], v[192:207]
    v_mfma_f32_32x32x16_bf16 v[208:223], a[56:59], a[236:239], v[208:223]
    v_mfma_f32_32x32x16_bf16 v[224:239], a[60:63], a[232:235], v[224:239]
    v_mfma_f32_32x32x16_bf16 v[240:255], a[60:63], a[236:239], v[240:255]
    s_add_u32 s62, s55, 38912
    buffer_load_dwordx4 a[56:59], v11, s[24:27], s62 offen sc1
    buffer_load_dwordx4 a[60:63], v5, s[24:27], s62 offen sc1
    s_waitcnt vmcnt(14)
    v_mfma_f32_32x32x16_bf16 v[192:207], a[64:67], a[240:243], v[192:207]
    v_mfma_f32_32x32x16_bf16 v[208:223], a[64:67], a[244:247], v[208:223]
    v_mfma_f32_32x32x16_bf16 v[224:239], a[68:71], a[240:243], v[224:239]
    v_mfma_f32_32x32x16_bf16 v[240:255], a[68:71], a[244:247], v[240:255]
    s_add_u32 s62, s55, s56
    s_add_u32 s62, s62, 32768
    buffer_load_dwordx4 a[64:67], v11, s[24:27], s62 offen sc1
    buffer_load_dwordx4 a[68:71], v5, s[24:27], s62 offen sc1
    s_waitcnt vmcnt(14)
    v_mfma_f32_32x32x16_bf16 v[192:207], a[72:75], a[248:251], v[192:207]
    v_mfma_f32_32x32x16_bf16 v[208:223], a[72:75], a[252:255], v[208:223]
    v_mfma_f32_32x32x16_bf16 v[224:239], a[76:79], a[248:251], v[224:239]
    v_mfma_f32_32x32x16_bf16 v[240:255], a[76:79], a[252:255], v[240:255]
    s_add_u32 s62, s55, s56
    s_add_u32 s62, s62, 34816
    buffer_load_dwordx4 a[72:75], v11, s[24:27], s62 offen sc1
    buffer_load_dwordx4 a[76:79], v5, s[24:27], s62 offen sc1
    s_waitcnt vmcnt(14)
    v_mfma_f32_32x32x16_bf16 v[64:79], a[80:83], a[0:3], v[64:79]
    v_mfma_f32_32x32x16_bf16 v[80:95], a[80:83], a[4:7], v[80:95]
    v_mfma_f32_32x32x16_bf16 v[96:111], a[84:87], a[0:3], v[96:111]
    v_mfma_f32_32x32x16_bf16 v[112:127], a[84:87], a[4:7], v[112:127]
    s_add_u32 s62, s55, s56
    s_add_u32 s62, s62, 40960
    buffer_load_dwordx4 a[80:83], v11, s[24:27], s62 offen sc1
    buffer_load_dwordx4 a[84:87], v5, s[24:27], s62 offen sc1
    s_waitcnt vmcnt(14)
    v_mfma_f32_32x32x16_bf16 v[64:79], a[88:91], a[8:11], v[64:79]
    v_mfma_f32_32x32x16_bf16 v[80:95], a[88:91], a[12:15], v[80:95]
    v_mfma_f32_32x32x16_bf16 v[96:111], a[92:95], a[8:11], v[96:111]
    v_mfma_f32_32x32x16_bf16 v[112:127], a[92:95], a[12:15], v[112:127]
    s_add_u32 s62, s55, s56
    s_add_u32 s62, s62, 43008
    buffer_load_dwordx4 a[88:91], v11, s[24:27], s62 offen sc1
    buffer_load_dwordx4 a[92:95], v5, s[24:27], s62 offen sc1
    s_waitcnt vmcnt(14)
    v_mfma_f32_32x32x16_bf16 v[64:79], a[96:99], a[16:19], v[64:79]
    v_mul_f32 v192, v12, v192
    v_mul_f32 v193, v13, v193
    v_mul_f32 v194, v14, v194
    v_mul_f32 v195, v15, v195
    v_mul_f32 v196, v16, v196
    v_mfma_f32_32x32x16_bf16 v[80:95], a[96:99], a[20:23], v[80:95]
    v_mul_f32 v197, v17, v197
    v_mul_f32 v198, v18, v198
    v_mul_f32 v199, v19, v199
    v_mul_f32 v200, v20, v200
    v_mul_f32 v201, v21, v201
    v_mfma_f32_32x32x16_bf16 v[96:111], a[100:103], a[16:19], v[96:111]
    v_mul_f32 v202, v22, v202
    v_mul_f32 v203, v23, v203
    v_mul_f32 v204, v24, v204
    v_mul_f32 v205, v25, v205
    v_mul_f32 v206, v26, v206
    v_mfma_f32_32x32x16_bf16 v[112:127], a[100:103], a[20:23], v[112:127]
    s_add_u32 s62, s54, s56
    s_add_u32 s62, s62, 4096
    buffer_load_dwordx4 a[96:99], v11, s[24:27], s62 offen sc1
    buffer_load_dwordx4 a[100:103], v5, s[24:27], s62 offen sc1
    v_mul_f32 v207, v27, v207
    s_waitcnt vmcnt(14)
    v_mfma_f32_32x32x16_bf16 v[64:79], a[104:107], a[24:27], v[64:79]
    v_mul_f32 v208, v12, v208
    v_mul_f32 v209, v13, v209
    v_mul_f32 v210, v14, v210
    v_mul_f32 v211, v15, v211
    v_mul_f32 v212, v16, v212
    v_mfma_f32_32x32x16_bf16 v[80:95], a[104:107], a[28:31], v[80:95]
    v_mul_f32 v213, v17, v213
    v_mul_f32 v214, v18, v214
    v_mul_f32 v215, v19, v215
    v_mul_f32 v216, v20, v216
    v_mul_f32 v217, v21, v217
    v_mfma_f32_32x32x16_bf16 v[96:111], a[108:111], a[24:27], v[96:111]
    v_mul_f32 v218, v22, v218
    v_mul_f32 v219, v23, v219
    v_mul_f32 v220, v24, v220
    v_mul_f32 v221, v25, v221
    v_mul_f32 v222, v26, v222
    v_mfma_f32_32x32x16_bf16 v[112:127], a[108:111], a[28:31], v[112:127]
    s_add_u32 s62, s54, s56
    s_add_u32 s62, s62, 6144
    buffer_load_dwordx4 a[104:107], v11, s[24:27], s62 offen sc1
    buffer_load_dwordx4 a[108:111], v5, s[24:27], s62 offen sc1
    v_mul_f32 v223, v27, v223
    s_waitcnt vmcnt(14)
    v_mfma_f32_32x32x16_bf16 v[64:79], a[48:51], a[32:35], v[64:79]
    v_mul_f32 v224, v28, v224
    v_mul_f32 v225, v29, v225
    v_mul_f32 v226, v30, v226
    v_mul_f32 v227, v31, v227
    v_mul_f32 v228, v32, v228
    v_mfma_f32_32x32x16_bf16 v[80:95], a[48:51], a[36:39], v[80:95]
    v_mul_f32 v229, v33, v229
    v_mul_f32 v230, v34, v230
    v_mul_f32 v231, v35, v231
    v_mul_f32 v232, v36, v232
    v_mul_f32 v233, v37, v233
    v_mfma_f32_32x32x16_bf16 v[96:111], a[52:55], a[32:35], v[96:111]
    v_mul_f32 v234, v38, v234
    v_mul_f32 v235, v39, v235
    v_mul_f32 v236, v40, v236
    v_mul_f32 v237, v41, v237
    v_mul_f32 v238, v42, v238
    v_mfma_f32_32x32x16_bf16 v[112:127], a[52:55], a[36:39], v[112:127]
    s_add_u32 s62, s54, s56
    s_add_u32 s62, s62, 12288
    buffer_load_dwordx4 a[48:51], v11, s[24:27], s62 offen sc1
    buffer_load_dwordx4 a[52:55], v5, s[24:27], s62 offen sc1
    v_mul_f32 v239, v43, v239
    s_waitcnt vmcnt(14)
    v_mfma_f32_32x32x16_bf16 v[64:79], a[56:59], a[40:43], v[64:79]
    v_mul_f32 v240, v28, v240
    v_mul_f32 v241, v29, v241
    v_mul_f32 v242, v30, v242
    v_mul_f32 v243, v31, v243
    v_mul_f32 v244, v32, v244
    v_mfma_f32_32x32x16_bf16 v[80:95], a[56:59], a[44:47], v[80:95]
    v_mul_f32 v245, v33, v245
    v_mul_f32 v246, v34, v246
    v_mul_f32 v247, v35, v247
    v_mul_f32 v248, v36, v248
    v_mul_f32 v249, v37, v249
    v_mfma_f32_32x32x16_bf16 v[96:111], a[60:63], a[40:43], v[96:111]
    v_mul_f32 v250, v38, v250
    v_mul_f32 v251, v39, v251
    v_mul_f32 v252, v40, v252
    v_mul_f32 v253, v41, v253
    v_mul_f32 v254, v42, v254
    v_mfma_f32_32x32x16_bf16 v[112:127], a[60:63], a[44:47], v[112:127]
    s_add_u32 s62, s54, s56
    s_add_u32 s62, s62, 14336
    buffer_load_dwordx4 a[56:59], v11, s[24:27], s62 offen sc1
    buffer_load_dwordx4 a[60:63], v5, s[24:27], s62 offen sc1
    v_mul_f32 v255, v43, v255
    s_waitcnt vmcnt(14)
    v_mfma_f32_32x32x16_bf16 v[128:143], a[64:67], a[160:163], v[128:143]
    v_sub_f32 v12, 1.0, v12
    v_sub_f32 v13, 1.0, v13
    v_sub_f32 v14, 1.0, v14
    v_sub_f32 v15, 1.0, v15
    v_sub_f32 v16, 1.0, v16
    v_mfma_f32_32x32x16_bf16 v[144:159], a[64:67], a[164:167], v[144:159]
    v_sub_f32 v17, 1.0, v17
    v_sub_f32 v18, 1.0, v18
    v_sub_f32 v19, 1.0, v19
    v_sub_f32 v20, 1.0, v20
    v_sub_f32 v21, 1.0, v21
    v_mfma_f32_32x32x16_bf16 v[160:175], a[68:71], a[160:163], v[160:175]
    v_sub_f32 v22, 1.0, v22
    v_sub_f32 v23, 1.0, v23
    v_sub_f32 v24, 1.0, v24
    v_sub_f32 v25, 1.0, v25
    v_sub_f32 v26, 1.0, v26
    v_mfma_f32_32x32x16_bf16 v[176:191], a[68:71], a[164:167], v[176:191]
    s_add_u32 s62, s55, s56
    s_add_u32 s62, s62, 36864
    buffer_load_dwordx4 a[64:67], v11, s[24:27], s62 offen sc1
    buffer_load_dwordx4 a[68:71], v5, s[24:27], s62 offen sc1
    v_sub_f32 v27, 1.0, v27
    v_sub_f32 v28, 1.0, v28
    v_sub_f32 v29, 1.0, v29
    v_sub_f32 v30, 1.0, v30
    v_sub_f32 v31, 1.0, v31
    v_sub_f32 v32, 1.0, v32
    v_sub_f32 v33, 1.0, v33
    v_sub_f32 v34, 1.0, v34
    v_sub_f32 v35, 1.0, v35
    v_sub_f32 v36, 1.0, v36
    v_sub_f32 v37, 1.0, v37
    v_sub_f32 v38, 1.0, v38
    v_sub_f32 v39, 1.0, v39
    v_sub_f32 v40, 1.0, v40
    v_sub_f32 v41, 1.0, v41
    v_sub_f32 v42, 1.0, v42
    v_sub_f32 v43, 1.0, v43
    s_nop 7
    v_pk_fma_f32 v[80:81], v[12:13], v[80:81], v[208:209]
    v_pk_fma_f32 v[82:83], v[14:15], v[82:83], v[210:211]
    v_pk_fma_f32 v[84:85], v[16:17], v[84:85], v[212:213]
    v_pk_fma_f32 v[86:87], v[18:19], v[86:87], v[214:215]
    v_pk_fma_f32 v[88:89], v[20:21], v[88:89], v[216:217]
    v_pk_fma_f32 v[90:91], v[22:23], v[90:91], v[218:219]
    v_pk_fma_f32 v[92:93], v[24:25], v[92:93], v[220:221]
    v_pk_fma_f32 v[94:95], v[26:27], v[94:95], v[222:223]
    v_pk_fma_f32 v[96:97], v[28:29], v[96:97], v[224:225]
    v_pk_fma_f32 v[98:99], v[30:31], v[98:99], v[226:227]
    v_pk_fma_f32 v[100:101], v[32:33], v[100:101], v[228:229]
    v_pk_fma_f32 v[102:103], v[34:35], v[102:103], v[230:231]
    v_pk_fma_f32 v[104:105], v[36:37], v[104:105], v[232:233]
    v_pk_fma_f32 v[106:107], v[38:39], v[106:107], v[234:235]
    v_pk_fma_f32 v[108:109], v[40:41], v[108:109], v[236:237]
    v_pk_fma_f32 v[110:111], v[42:43], v[110:111], v[238:239]
    v_pk_fma_f32 v[112:113], v[28:29], v[112:113], v[240:241]
    v_pk_fma_f32 v[114:115], v[30:31], v[114:115], v[242:243]
    v_pk_fma_f32 v[116:117], v[32:33], v[116:117], v[244:245]
    v_pk_fma_f32 v[118:119], v[34:35], v[118:119], v[246:247]
    v_pk_fma_f32 v[120:121], v[36:37], v[120:121], v[248:249]
    v_pk_fma_f32 v[122:123], v[38:39], v[122:123], v[250:251]
    v_pk_fma_f32 v[124:125], v[40:41], v[124:125], v[252:253]
    v_pk_fma_f32 v[126:127], v[42:43], v[126:127], v[254:255]
    v_pk_fma_f32 v[64:65], v[12:13], v[64:65], v[192:193]
    v_pk_fma_f32 v[66:67], v[14:15], v[66:67], v[194:195]
    v_pk_fma_f32 v[68:69], v[16:17], v[68:69], v[196:197]
    v_pk_fma_f32 v[70:71], v[18:19], v[70:71], v[198:199]
    v_pk_fma_f32 v[72:73], v[20:21], v[72:73], v[200:201]
    v_pk_fma_f32 v[74:75], v[22:23], v[74:75], v[202:203]
    v_pk_fma_f32 v[76:77], v[24:25], v[76:77], v[204:205]
    v_pk_fma_f32 v[78:79], v[26:27], v[78:79], v[206:207]
    s_waitcnt vmcnt(14)
    v_mfma_f32_32x32x16_bf16 v[128:143], a[72:75], a[168:171], v[128:143]
    s_xor_b32 s62, s50, 1
    s_mul_i32 s62, s62, 12288
    v_add_u32 v2, s62, v60
    ds_write_b128 v2, v[80:83] offset:0
    v_mfma_f32_32x32x16_bf16 v[144:159], a[72:75], a[172:175], v[144:159]
    s_lshl_b32 s63, s81, 1
    s_add_u32 s63, s63, s83
    s_lshl_b32 s63, s63, 8
    s_add_u32 s63, s63, 15728640
    s_xor_b32 s62, s52, 0
    s_lshl_b32 s62, s62, 7
    v_lshlrev_b32 v7, 6, v61
    v_add_u32 v7, s62, v7
    buffer_load_dwordx4 v[12:15], v7, s[24:27], s63 offen offset:0 sc1
    buffer_load_dwordx4 v[16:19], v7, s[24:27], s63 offen offset:16 sc1
    buffer_load_dwordx4 v[20:23], v7, s[24:27], s63 offen offset:32 sc1
    buffer_load_dwordx4 v[24:27], v7, s[24:27], s63 offen offset:48 sc1
    v_mfma_f32_32x32x16_bf16 v[160:175], a[76:79], a[168:171], v[160:175]
    ds_write_b128 v2, v[84:87] offset:1024
    ds_write_b128 v2, v[88:91] offset:2048
    v_mfma_f32_32x32x16_bf16 v[176:191], a[76:79], a[172:175], v[176:191]
    s_lshl_b32 s63, s81, 1
    s_add_u32 s63, s63, s83
    s_lshl_b32 s63, s63, 8
    s_add_u32 s63, s63, 15728640
    s_xor_b32 s62, s52, 1
    s_lshl_b32 s62, s62, 7
    v_lshlrev_b32 v7, 6, v61
    v_add_u32 v7, s62, v7
    buffer_load_dwordx4 v[28:31], v7, s[24:27], s63 offen offset:0 sc1
    buffer_load_dwordx4 v[32:35], v7, s[24:27], s63 offen offset:16 sc1
    buffer_load_dwordx4 v[36:39], v7, s[24:27], s63 offen offset:32 sc1
    buffer_load_dwordx4 v[40:43], v7, s[24:27], s63 offen offset:48 sc1
    s_waitcnt vmcnt(20)
    v_mfma_f32_32x32x16_bf16 v[128:143], a[80:83], a[176:179], v[128:143]
    ds_write_b128 v2, v[92:95] offset:3072
    s_xor_b32 s62, s50, 2
    s_mul_i32 s62, s62, 12288
    v_add_u32 v2, s62, v60
    v_mfma_f32_32x32x16_bf16 v[144:159], a[80:83], a[180:183], v[144:159]
    s_add_u32 s62, s55, s56
    s_add_u32 s62, s62, 38912
    buffer_load_dwordx4 a[72:75], v11, s[24:27], s62 offen sc1
    buffer_load_dwordx4 a[76:79], v5, s[24:27], s62 offen sc1
    ds_write_b128 v2, v[96:99] offset:4096
    v_mfma_f32_32x32x16_bf16 v[160:175], a[84:87], a[176:179], v[160:175]
    ds_write_b128 v2, v[100:103] offset:5120
    ds_write_b128 v2, v[104:107] offset:6144
    v_mfma_f32_32x32x16_bf16 v[176:191], a[84:87], a[180:183], v[176:191]
    s_add_u32 s62, s53, s56
    s_add_u32 s62, s62, 0
    buffer_load_dwordx4 a[80:83], v11, s[24:27], s62 offen sc1
    buffer_load_dwordx4 a[84:87], v5, s[24:27], s62 offen sc1
    ds_write_b128 v2, v[108:111] offset:7168
    s_waitcnt vmcnt(22)
    v_mfma_f32_32x32x16_bf16 v[128:143], a[88:91], a[184:187], v[128:143]
    s_xor_b32 s62, s50, 3
    s_mul_i32 s62, s62, 12288
    v_add_u32 v2, s62, v60
    ds_write_b128 v2, v[112:115] offset:8192
    v_mfma_f32_32x32x16_bf16 v[144:159], a[88:91], a[188:191], v[144:159]
    ds_write_b128 v2, v[116:119] offset:9216
    ds_write_b128 v2, v[120:123] offset:10240
    v_mfma_f32_32x32x16_bf16 v[160:175], a[92:95], a[184:187], v[160:175]
    ds_write_b128 v2, v[124:127] offset:11264
    s_mul_i32 s62, s50, 12288
    s_waitcnt lgkmcnt(0)
    s_barrier
    v_add_u32 v2, s62, v60
    v_mfma_f32_32x32x16_bf16 v[176:191], a[92:95], a[188:191], v[176:191]
    s_add_u32 s62, s53, s56
    s_add_u32 s62, s62, 2048
    buffer_load_dwordx4 a[88:91], v11, s[24:27], s62 offen sc1
    buffer_load_dwordx4 a[92:95], v5, s[24:27], s62 offen sc1
    ds_read_b128 v[80:83], v2 offset:0
    s_waitcnt vmcnt(22)
    v_mfma_f32_32x32x16_bf16 v[128:143], a[96:99], a[0:3], v[128:143]
    ds_read_b128 v[84:87], v2 offset:1024
    ds_read_b128 v[88:91], v2 offset:2048
    ds_read_b128 v[92:95], v2 offset:3072
    ds_read_b128 v[96:99], v2 offset:4096
    ds_read_b128 v[100:103], v2 offset:5120
    v_mfma_f32_32x32x16_bf16 v[144:159], a[96:99], a[4:7], v[144:159]
    ds_read_b128 v[104:107], v2 offset:6144
    ds_read_b128 v[108:111], v2 offset:7168
    ds_read_b128 v[112:115], v2 offset:8192
    ds_read_b128 v[116:119], v2 offset:9216
    ds_read_b128 v[120:123], v2 offset:10240
    v_mfma_f32_32x32x16_bf16 v[160:175], a[100:103], a[0:3], v[160:175]
    ds_read_b128 v[124:127], v2 offset:11264
    s_waitcnt lgkmcnt(8)
    v_pk_add_f32 v[64:65], v[64:65], v[80:81]
    v_pk_add_f32 v[66:67], v[66:67], v[82:83]
    v_pk_add_f32 v[68:69], v[68:69], v[84:85]
    v_pk_add_f32 v[70:71], v[70:71], v[86:87]
    v_pk_add_f32 v[72:73], v[72:73], v[88:89]
    v_pk_add_f32 v[74:75], v[74:75], v[90:91]
    v_pk_add_f32 v[76:77], v[76:77], v[92:93]
    v_pk_add_f32 v[78:79], v[78:79], v[94:95]
    s_waitcnt lgkmcnt(4)
    v_pk_add_f32 v[64:65], v[64:65], v[96:97]
    v_pk_add_f32 v[66:67], v[66:67], v[98:99]
    v_pk_add_f32 v[68:69], v[68:69], v[100:101]
    v_pk_add_f32 v[70:71], v[70:71], v[102:103]
    v_pk_add_f32 v[72:73], v[72:73], v[104:105]
    v_pk_add_f32 v[74:75], v[74:75], v[106:107]
    v_pk_add_f32 v[76:77], v[76:77], v[108:109]
    v_pk_add_f32 v[78:79], v[78:79], v[110:111]
    s_waitcnt lgkmcnt(0)
    v_pk_add_f32 v[64:65], v[64:65], v[112:113]
    v_pk_add_f32 v[66:67], v[66:67], v[114:115]
    v_pk_add_f32 v[68:69], v[68:69], v[116:117]
    v_pk_add_f32 v[70:71], v[70:71], v[118:119]
    v_pk_add_f32 v[72:73], v[72:73], v[120:121]
    v_pk_add_f32 v[74:75], v[74:75], v[122:123]
    v_pk_add_f32 v[76:77], v[76:77], v[124:125]
    v_pk_add_f32 v[78:79], v[78:79], v[126:127]
    s_lshl_b32 s62, s57, 12
    s_add_u32 s62, s62, 16777216
    buffer_store_dwordx4 v[64:67], v60, s[24:27], s62 offen offset:0 sc1
    buffer_store_dwordx4 v[68:71], v60, s[24:27], s62 offen offset:1024 sc1
    buffer_store_dwordx4 v[72:75], v60, s[24:27], s62 offen offset:2048 sc1
    buffer_store_dwordx4 v[76:79], v60, s[24:27], s62 offen offset:3072 sc1
    v_mfma_f32_32x32x16_bf16 v[176:191], a[100:103], a[4:7], v[176:191]
    s_add_u32 s62, s53, s56
    s_add_u32 s62, s62, 4096
    buffer_load_dwordx4 a[96:99], v11, s[24:27], s62 offen sc1
    buffer_load_dwordx4 a[100:103], v5, s[24:27], s62 offen sc1
    s_waitcnt vmcnt(12)
    v_mfma_f32_32x32x16_bf16 v[128:143], a[104:107], a[8:11], v[128:143]
    v_mul_f32 v44, v44, v10
    v_mul_f32 v45, v45, v10
    v_mul_f32 v46, v46, v10
    v_mul_f32 v47, v47, v10
    v_mul_f32 v48, v48, v10
    v_mfma_f32_32x32x16_bf16 v[144:159], a[104:107], a[12:15], v[144:159]
    v_mul_f32 v49, v49, v10
    v_mul_f32 v50, v50, v10
    v_mul_f32 v51, v51, v10
    v_mul_f32 v52, v52, v10
    v_mul_f32 v53, v53, v10
    v_mfma_f32_32x32x16_bf16 v[160:175], a[108:111], a[8:11], v[160:175]
    v_mul_f32 v54, v54, v10
    v_mul_f32 v55, v55, v10
    v_mul_f32 v56, v56, v10
    v_mul_f32 v57, v57, v10
    v_mul_f32 v58, v58, v10
    v_mfma_f32_32x32x16_bf16 v[176:191], a[108:111], a[12:15], v[176:191]
    s_add_u32 s62, s53, s56
    s_add_u32 s62, s62, 6144
    buffer_load_dwordx4 a[104:107], v11, s[24:27], s62 offen sc1
    buffer_load_dwordx4 a[108:111], v5, s[24:27], s62 offen sc1
    v_mul_f32 v59, v59, v10
    v_mfma_f32_32x32x16_bf16 v[128:143], a[48:51], a[16:19], v[128:143]
    v_mul_f32 v44, v44, v12
    v_mul_f32 v45, v45, v13
    v_mul_f32 v46, v46, v14
    v_mul_f32 v47, v47, v15
    v_mul_f32 v48, v48, v16
    v_mfma_f32_32x32x16_bf16 v[144:159], a[48:51], a[20:23], v[144:159]
    v_mul_f32 v49, v49, v17
    v_mul_f32 v50, v50, v18
    v_mul_f32 v51, v51, v19
    v_mul_f32 v52, v52, v20
    v_mul_f32 v53, v53, v21
    v_mfma_f32_32x32x16_bf16 v[160:175], a[52:55], a[16:19], v[160:175]
    v_mul_f32 v54, v54, v22
    v_mul_f32 v55, v55, v23
    v_mul_f32 v56, v56, v24
    v_mul_f32 v57, v57, v25
    v_mul_f32 v58, v58, v26
    v_mfma_f32_32x32x16_bf16 v[176:191], a[52:55], a[20:23], v[176:191]
    s_add_u32 s62, s53, s56
    s_add_u32 s62, s62, 8192
    buffer_load_dwordx4 a[48:51], v11, s[24:27], s62 offen sc1
    buffer_load_dwordx4 a[52:55], v5, s[24:27], s62 offen sc1
    v_mul_f32 v59, v59, v27
    v_mfma_f32_32x32x16_bf16 v[128:143], a[56:59], a[24:27], v[128:143]
    v_mfma_f32_32x32x16_bf16 v[144:159], a[56:59], a[28:31], v[144:159]
    v_mfma_f32_32x32x16_bf16 v[160:175], a[60:63], a[24:27], v[160:175]
    v_mfma_f32_32x32x16_bf16 v[176:191], a[60:63], a[28:31], v[176:191]
    s_add_u32 s62, s53, s56
    s_add_u32 s62, s62, 10240
    buffer_load_dwordx4 a[56:59], v11, s[24:27], s62 offen sc1
    buffer_load_dwordx4 a[60:63], v5, s[24:27], s62 offen sc1
    v_mfma_f32_32x32x16_bf16 v[128:143], a[64:67], a[32:35], v[128:143]
    v_mfma_f32_32x32x16_bf16 v[144:159], a[64:67], a[36:39], v[144:159]
    v_mfma_f32_32x32x16_bf16 v[160:175], a[68:71], a[32:35], v[160:175]
    v_mfma_f32_32x32x16_bf16 v[176:191], a[68:71], a[36:39], v[176:191]
    s_add_u32 s62, s53, s56
    s_add_u32 s62, s62, 12288
    buffer_load_dwordx4 a[64:67], v11, s[24:27], s62 offen sc1
    buffer_load_dwordx4 a[68:71], v5, s[24:27], s62 offen sc1
    s_waitcnt vmcnt(18)
    v_mfma_f32_32x32x16_bf16 v[128:143], a[72:75], a[40:43], v[128:143]
    v_mfma_f32_32x32x16_bf16 v[144:159], a[72:75], a[44:47], v[144:159]
    v_mfma_f32_32x32x16_bf16 v[160:175], a[76:79], a[40:43], v[160:175]
    v_mfma_f32_32x32x16_bf16 v[176:191], a[76:79], a[44:47], v[176:191]
    s_add_u32 s62, s53, s56
    s_add_u32 s62, s62, 14336
    buffer_load_dwordx4 a[72:75], v11, s[24:27], s62 offen sc1
    buffer_load_dwordx4 a[76:79], v5, s[24:27], s62 offen sc1
    s_waitcnt vmcnt(12)
    s_lshl_b32 s62, s57, 7
    s_add_u32 s62, s62, 16121856
    v_cmp_eq_u32 vcc, 0, v1
    v_mov_b32 v7, s100
    v_mov_b32 v9, s62
    v_cndmask_b32 v7, v7, v9, vcc
    v_mov_b32 v9, s101
    buffer_store_dword v9, v7, s[24:27], 0 offen sc1
    s_lshl_b32 s62, s58, 7
    s_add_u32 s62, s62, 16121856
    v_mov_b32 v8, s62
    v_mfma_f32_32x32x16_bf16 v[192:207], a[80:83], a[192:195], 0
    v_mfma_f32_32x32x16_bf16 v[208:223], a[80:83], a[196:199], 0
    v_mfma_f32_32x32x16_bf16 v[224:239], a[84:87], a[192:195], 0
    v_mfma_f32_32x32x16_bf16 v[240:255], a[84:87], a[196:199], 0
    v_mfma_f32_32x32x16_bf16 v[192:207], a[88:91], a[200:203], v[192:207]
    v_mfma_f32_32x32x16_bf16 v[208:223], a[88:91], a[204:207], v[208:223]
    v_mfma_f32_32x32x16_bf16 v[224:239], a[92:95], a[200:203], v[224:239]
    v_mfma_f32_32x32x16_bf16 v[240:255], a[92:95], a[204:207], v[240:255]
    s_waitcnt vmcnt(11)
    v_mfma_f32_32x32x16_bf16 v[192:207], a[96:99], a[208:211], v[192:207]
    v_mfma_f32_32x32x16_bf16 v[208:223], a[96:99], a[212:215], v[208:223]
    v_mfma_f32_32x32x16_bf16 v[224:239], a[100:103], a[208:211], v[224:239]
    v_mfma_f32_32x32x16_bf16 v[240:255], a[100:103], a[212:215], v[240:255]
    s_waitcnt vmcnt(9)
    v_mfma_f32_32x32x16_bf16 v[192:207], a[104:107], a[216:219], v[192:207]
    v_mfma_f32_32x32x16_bf16 v[208:223], a[104:107], a[220:223], v[208:223]
    v_mfma_f32_32x32x16_bf16 v[224:239], a[108:111], a[216:219], v[224:239]
    v_mfma_f32_32x32x16_bf16 v[240:255], a[108:111], a[220:223], v[240:255]
    s_waitcnt vmcnt(7)
    v_mfma_f32_32x32x16_bf16 v[192:207], a[48:51], a[224:227], v[192:207]
    v_mfma_f32_32x32x16_bf16 v[208:223], a[48:51], a[228:231], v[208:223]
    v_mfma_f32_32x32x16_bf16 v[224:239], a[52:55], a[224:227], v[224:239]
    v_mfma_f32_32x32x16_bf16 v[240:255], a[52:55], a[228:231], v[240:255]
    s_waitcnt vmcnt(5)
    v_mfma_f32_32x32x16_bf16 v[192:207], a[56:59], a[232:235], v[192:207]
    v_mfma_f32_32x32x16_bf16 v[208:223], a[56:59], a[236:239], v[208:223]
    v_mfma_f32_32x32x16_bf16 v[224:239], a[60:63], a[232:235], v[224:239]
    v_mfma_f32_32x32x16_bf16 v[240:255], a[60:63], a[236:239], v[240:255]
    s_waitcnt vmcnt(3)
    v_mfma_f32_32x32x16_bf16 v[192:207], a[64:67], a[240:243], v[192:207]
    v_mfma_f32_32x32x16_bf16 v[208:223], a[64:67], a[244:247], v[208:223]
    v_mfma_f32_32x32x16_bf16 v[224:239], a[68:71], a[240:243], v[224:239]
    v_mfma_f32_32x32x16_bf16 v[240:255], a[68:71], a[244:247], v[240:255]
    s_waitcnt vmcnt(1)
    v_mfma_f32_32x32x16_bf16 v[192:207], a[72:75], a[248:251], v[192:207]
    v_mfma_f32_32x32x16_bf16 v[208:223], a[72:75], a[252:255], v[208:223]
    v_mfma_f32_32x32x16_bf16 v[224:239], a[76:79], a[248:251], v[224:239]
    v_mfma_f32_32x32x16_bf16 v[240:255], a[76:79], a[252:255], v[240:255]
    s_nop 7
    s_nop 7
    buffer_load_dword v9, v8, s[24:27], 0 offen sc1
    v_pk_add_f32 v[208:209], v[208:209], v[144:145] neg_lo:[0,1] neg_hi:[0,1]
    v_pk_add_f32 v[210:211], v[210:211], v[146:147] neg_lo:[0,1] neg_hi:[0,1]
    v_pk_add_f32 v[212:213], v[212:213], v[148:149] neg_lo:[0,1] neg_hi:[0,1]
    v_pk_add_f32 v[214:215], v[214:215], v[150:151] neg_lo:[0,1] neg_hi:[0,1]
    v_pk_add_f32 v[216:217], v[216:217], v[152:153] neg_lo:[0,1] neg_hi:[0,1]
    v_pk_add_f32 v[218:219], v[218:219], v[154:155] neg_lo:[0,1] neg_hi:[0,1]
    v_pk_add_f32 v[220:221], v[220:221], v[156:157] neg_lo:[0,1] neg_hi:[0,1]
    v_pk_add_f32 v[222:223], v[222:223], v[158:159] neg_lo:[0,1] neg_hi:[0,1]
    v_pk_fma_f32 v[144:145], v[12:13], v[208:209], v[144:145]
    v_pk_fma_f32 v[146:147], v[14:15], v[210:211], v[146:147]
    v_pk_fma_f32 v[148:149], v[16:17], v[212:213], v[148:149]
    v_pk_fma_f32 v[150:151], v[18:19], v[214:215], v[150:151]
    v_pk_fma_f32 v[152:153], v[20:21], v[216:217], v[152:153]
    v_pk_fma_f32 v[154:155], v[22:23], v[218:219], v[154:155]
    v_pk_fma_f32 v[156:157], v[24:25], v[220:221], v[156:157]
    v_pk_fma_f32 v[158:159], v[26:27], v[222:223], v[158:159]
    v_pk_add_f32 v[224:225], v[224:225], v[160:161] neg_lo:[0,1] neg_hi:[0,1]
    v_pk_add_f32 v[226:227], v[226:227], v[162:163] neg_lo:[0,1] neg_hi:[0,1]
    v_pk_add_f32 v[228:229], v[228:229], v[164:165] neg_lo:[0,1] neg_hi:[0,1]
    v_pk_add_f32 v[230:231], v[230:231], v[166:167] neg_lo:[0,1] neg_hi:[0,1]
    v_pk_add_f32 v[232:233], v[232:233], v[168:169] neg_lo:[0,1] neg_hi:[0,1]
    v_pk_add_f32 v[234:235], v[234:235], v[170:171] neg_lo:[0,1] neg_hi:[0,1]
    v_pk_add_f32 v[236:237], v[236:237], v[172:173] neg_lo:[0,1] neg_hi:[0,1]
    v_pk_add_f32 v[238:239], v[238:239], v[174:175] neg_lo:[0,1] neg_hi:[0,1]
    v_pk_fma_f32 v[160:161], v[28:29], v[224:225], v[160:161]
    v_pk_fma_f32 v[162:163], v[30:31], v[226:227], v[162:163]
    v_pk_fma_f32 v[164:165], v[32:33], v[228:229], v[164:165]
    v_pk_fma_f32 v[166:167], v[34:35], v[230:231], v[166:167]
    v_pk_fma_f32 v[168:169], v[36:37], v[232:233], v[168:169]
    v_pk_fma_f32 v[170:171], v[38:39], v[234:235], v[170:171]
    v_pk_fma_f32 v[172:173], v[40:41], v[236:237], v[172:173]
    v_pk_fma_f32 v[174:175], v[42:43], v[238:239], v[174:175]
    v_pk_add_f32 v[240:241], v[240:241], v[176:177] neg_lo:[0,1] neg_hi:[0,1]
    v_pk_add_f32 v[242:243], v[242:243], v[178:179] neg_lo:[0,1] neg_hi:[0,1]
    v_pk_add_f32 v[244:245], v[244:245], v[180:181] neg_lo:[0,1] neg_hi:[0,1]
    v_pk_add_f32 v[246:247], v[246:247], v[182:183] neg_lo:[0,1] neg_hi:[0,1]
    v_pk_add_f32 v[248:249], v[248:249], v[184:185] neg_lo:[0,1] neg_hi:[0,1]
    v_pk_add_f32 v[250:251], v[250:251], v[186:187] neg_lo:[0,1] neg_hi:[0,1]
    v_pk_add_f32 v[252:253], v[252:253], v[188:189] neg_lo:[0,1] neg_hi:[0,1]
    v_pk_add_f32 v[254:255], v[254:255], v[190:191] neg_lo:[0,1] neg_hi:[0,1]
    v_pk_fma_f32 v[176:177], v[28:29], v[240:241], v[176:177]
    v_pk_fma_f32 v[178:179], v[30:31], v[242:243], v[178:179]
    v_pk_fma_f32 v[180:181], v[32:33], v[244:245], v[180:181]
    v_pk_fma_f32 v[182:183], v[34:35], v[246:247], v[182:183]
    v_pk_fma_f32 v[184:185], v[36:37], v[248:249], v[184:185]
    v_pk_fma_f32 v[186:187], v[38:39], v[250:251], v[186:187]
    v_pk_fma_f32 v[188:189], v[40:41], v[252:253], v[188:189]
    v_pk_fma_f32 v[190:191], v[42:43], v[254:255], v[190:191]
    v_pk_add_f32 v[192:193], v[192:193], v[128:129] neg_lo:[0,1] neg_hi:[0,1]
    v_pk_add_f32 v[194:195], v[194:195], v[130:131] neg_lo:[0,1] neg_hi:[0,1]
    v_pk_add_f32 v[196:197], v[196:197], v[132:133] neg_lo:[0,1] neg_hi:[0,1]
    v_pk_add_f32 v[198:199], v[198:199], v[134:135] neg_lo:[0,1] neg_hi:[0,1]
    v_pk_add_f32 v[200:201], v[200:201], v[136:137] neg_lo:[0,1] neg_hi:[0,1]
    v_pk_add_f32 v[202:203], v[202:203], v[138:139] neg_lo:[0,1] neg_hi:[0,1]
    v_pk_add_f32 v[204:205], v[204:205], v[140:141] neg_lo:[0,1] neg_hi:[0,1]
    v_pk_add_f32 v[206:207], v[206:207], v[142:143] neg_lo:[0,1] neg_hi:[0,1]
    v_pk_fma_f32 v[128:129], v[12:13], v[192:193], v[128:129]
    v_pk_fma_f32 v[130:131], v[14:15], v[194:195], v[130:131]
    v_pk_fma_f32 v[132:133], v[16:17], v[196:197], v[132:133]
    v_pk_fma_f32 v[134:135], v[18:19], v[198:199], v[134:135]
    v_pk_fma_f32 v[136:137], v[20:21], v[200:201], v[136:137]
    v_pk_fma_f32 v[138:139], v[22:23], v[202:203], v[138:139]
    v_pk_fma_f32 v[140:141], v[24:25], v[204:205], v[140:141]
    v_pk_fma_f32 v[142:143], v[26:27], v[206:207], v[142:143]
    s_barrier
    s_xor_b32 s62, s50, 1
    s_mul_i32 s62, s62, 12288
    v_add_u32 v2, s62, v60
    ds_write_b128 v2, v[144:147] offset:0
    ds_write_b128 v2, v[148:151] offset:1024
    ds_write_b128 v2, v[152:155] offset:2048
    ds_write_b128 v2, v[156:159] offset:3072
    s_xor_b32 s62, s50, 2
    s_mul_i32 s62, s62, 12288
    v_add_u32 v2, s62, v60
    ds_write_b128 v2, v[160:163] offset:4096
    ds_write_b128 v2, v[164:167] offset:5120
    ds_write_b128 v2, v[168:171] offset:6144
    ds_write_b128 v2, v[172:175] offset:7168
    s_xor_b32 s62, s50, 3
    s_mul_i32 s62, s62, 12288
    v_add_u32 v2, s62, v60
    ds_write_b128 v2, v[176:179] offset:8192
    ds_write_b128 v2, v[180:183] offset:9216
    ds_write_b128 v2, v[184:187] offset:10240
    ds_write_b128 v2, v[188:191] offset:11264
    s_waitcnt vmcnt(0)
gated_mix__ssm_conv_s5__glu_gated_geglu__prompt_kernel_chk_x:
    v_cmp_eq_u32 vcc, s101, v9
    s_and_b32 s60, vcc_lo, 0x1
    s_cmp_eq_u32 s60, 0x1
    s_cbranch_scc0 gated_mix__ssm_conv_s5__glu_gated_geglu__prompt_kernel_spin_x
gated_mix__ssm_conv_s5__glu_gated_geglu__prompt_kernel_ok_x:
    s_lshl_b32 s62, s58, 12
    s_add_u32 s62, s62, 16777216
    buffer_load_dwordx4 v[80:83], v60, s[24:27], s62 offen offset:0 sc1
    buffer_load_dwordx4 v[84:87], v60, s[24:27], s62 offen offset:1024 sc1
    buffer_load_dwordx4 v[88:91], v60, s[24:27], s62 offen offset:2048 sc1
    buffer_load_dwordx4 v[92:95], v60, s[24:27], s62 offen offset:3072 sc1
    s_mul_i32 s62, s50, 12288
    v_add_u32 v2, s62, v60
    s_waitcnt lgkmcnt(0)
    s_barrier
    ds_read_b128 v[208:211], v2 offset:0
    ds_read_b128 v[212:215], v2 offset:1024
    ds_read_b128 v[216:219], v2 offset:2048
    ds_read_b128 v[220:223], v2 offset:3072
    ds_read_b128 v[224:227], v2 offset:4096
    ds_read_b128 v[228:231], v2 offset:5120
    ds_read_b128 v[232:235], v2 offset:6144
    ds_read_b128 v[236:239], v2 offset:7168
    ds_read_b128 v[240:243], v2 offset:8192
    ds_read_b128 v[244:247], v2 offset:9216
    ds_read_b128 v[248:251], v2 offset:10240
    ds_read_b128 v[252:255], v2 offset:11264
    v_pk_add_f32 v[128:129], v[128:129], v[44:45]
    v_pk_add_f32 v[130:131], v[130:131], v[46:47]
    v_pk_add_f32 v[132:133], v[132:133], v[48:49]
    v_pk_add_f32 v[134:135], v[134:135], v[50:51]
    v_pk_add_f32 v[136:137], v[136:137], v[52:53]
    v_pk_add_f32 v[138:139], v[138:139], v[54:55]
    v_pk_add_f32 v[140:141], v[140:141], v[56:57]
    v_pk_add_f32 v[142:143], v[142:143], v[58:59]
    s_waitcnt lgkmcnt(8)
    v_pk_add_f32 v[128:129], v[128:129], v[208:209]
    v_pk_add_f32 v[130:131], v[130:131], v[210:211]
    v_pk_add_f32 v[132:133], v[132:133], v[212:213]
    v_pk_add_f32 v[134:135], v[134:135], v[214:215]
    v_pk_add_f32 v[136:137], v[136:137], v[216:217]
    v_pk_add_f32 v[138:139], v[138:139], v[218:219]
    v_pk_add_f32 v[140:141], v[140:141], v[220:221]
    v_pk_add_f32 v[142:143], v[142:143], v[222:223]
    s_waitcnt lgkmcnt(4)
    v_pk_add_f32 v[128:129], v[128:129], v[224:225]
    v_pk_add_f32 v[130:131], v[130:131], v[226:227]
    v_pk_add_f32 v[132:133], v[132:133], v[228:229]
    v_pk_add_f32 v[134:135], v[134:135], v[230:231]
    v_pk_add_f32 v[136:137], v[136:137], v[232:233]
    v_pk_add_f32 v[138:139], v[138:139], v[234:235]
    v_pk_add_f32 v[140:141], v[140:141], v[236:237]
    v_pk_add_f32 v[142:143], v[142:143], v[238:239]
    s_waitcnt lgkmcnt(0)
    v_pk_add_f32 v[128:129], v[128:129], v[240:241]
    v_pk_add_f32 v[130:131], v[130:131], v[242:243]
    v_pk_add_f32 v[132:133], v[132:133], v[244:245]
    v_pk_add_f32 v[134:135], v[134:135], v[246:247]
    v_pk_add_f32 v[136:137], v[136:137], v[248:249]
    v_pk_add_f32 v[138:139], v[138:139], v[250:251]
    v_pk_add_f32 v[140:141], v[140:141], v[252:253]
    v_pk_add_f32 v[142:143], v[142:143], v[254:255]
    s_waitcnt vmcnt(0)
    v_pk_add_f32 v[128:129], v[128:129], v[80:81]
    v_pk_add_f32 v[130:131], v[130:131], v[82:83]
    v_pk_add_f32 v[132:133], v[132:133], v[84:85]
    v_pk_add_f32 v[134:135], v[134:135], v[86:87]
    v_pk_add_f32 v[136:137], v[136:137], v[88:89]
    v_pk_add_f32 v[138:139], v[138:139], v[90:91]
    v_pk_add_f32 v[140:141], v[140:141], v[92:93]
    v_pk_add_f32 v[142:143], v[142:143], v[94:95]
    buffer_store_dword v128, v4, s[88:91], s95 offen offset:0
    buffer_store_dword v129, v4, s[88:91], s95 offen offset:2048
    s_add_u32 s95, s95, 4096
    buffer_store_dword v130, v4, s[88:91], s95 offen offset:0
    buffer_store_dword v131, v4, s[88:91], s95 offen offset:2048
    s_add_u32 s95, s95, 4096
    buffer_store_dword v132, v4, s[88:91], s95 offen offset:0
    buffer_store_dword v133, v4, s[88:91], s95 offen offset:2048
    s_add_u32 s95, s95, 4096
    buffer_store_dword v134, v4, s[88:91], s95 offen offset:0
    buffer_store_dword v135, v4, s[88:91], s95 offen offset:2048
    s_add_u32 s95, s95, 4096
    buffer_store_dword v136, v4, s[88:91], s95 offen offset:0
    buffer_store_dword v137, v4, s[88:91], s95 offen offset:2048
    s_add_u32 s95, s95, 4096
    buffer_store_dword v138, v4, s[88:91], s95 offen offset:0
    buffer_store_dword v139, v4, s[88:91], s95 offen offset:2048
    s_add_u32 s95, s95, 4096
    buffer_store_dword v140, v4, s[88:91], s95 offen offset:0
    buffer_store_dword v141, v4, s[88:91], s95 offen offset:2048
    s_add_u32 s95, s95, 4096
    buffer_store_dword v142, v4, s[88:91], s95 offen offset:0
    buffer_store_dword v143, v4, s[88:91], s95 offen offset:2048
gated_mix__ssm_conv_s5__glu_gated_geglu__prompt_kernel_end:
    s_endpgm
gated_mix__ssm_conv_s5__glu_gated_geglu__prompt_kernel_spin_n:
    s_add_u32 s99, s99, 1
    s_cmp_gt_u32 s99, 40000
    s_cbranch_scc1 gated_mix__ssm_conv_s5__glu_gated_geglu__prompt_kernel_ok_n
    s_sleep 4
    buffer_load_dword v55, v54, s[28:31], 0 offen sc1
    s_waitcnt vmcnt(0)
    s_branch gated_mix__ssm_conv_s5__glu_gated_geglu__prompt_kernel_chk_n
gated_mix__ssm_conv_s5__glu_gated_geglu__prompt_kernel_spin_wf:
    s_add_u32 s99, s99, 1
    s_cmp_gt_u32 s99, 40000
    s_cbranch_scc1 gated_mix__ssm_conv_s5__glu_gated_geglu__prompt_kernel_ok_wf
    s_sleep 4
    buffer_load_dword v25, v24, s[24:27], 0 offen sc1
    s_waitcnt vmcnt(0)
    s_branch gated_mix__ssm_conv_s5__glu_gated_geglu__prompt_kernel_chk_wf
gated_mix__ssm_conv_s5__glu_gated_geglu__prompt_kernel_spin_h2:
    s_add_u32 s99, s99, 1
    s_cmp_gt_u32 s99, 40000
    s_cbranch_scc1 gated_mix__ssm_conv_s5__glu_gated_geglu__prompt_kernel_ok_h2
    s_sleep 4
    buffer_load_dword v22, v20, s[24:27], 0 offen sc1
    s_waitcnt vmcnt(0)
    s_branch gated_mix__ssm_conv_s5__glu_gated_geglu__prompt_kernel_chk_h2
gated_mix__ssm_conv_s5__glu_gated_geglu__prompt_kernel_spin_g:
    s_add_u32 s99, s99, 1
    s_cmp_gt_u32 s99, 40000
    s_cbranch_scc1 gated_mix__ssm_conv_s5__glu_gated_geglu__prompt_kernel_ok_g
    s_sleep 4
    buffer_load_dword v7, v6, s[24:27], 0 offen sc1
    s_waitcnt vmcnt(0)
    s_branch gated_mix__ssm_conv_s5__glu_gated_geglu__prompt_kernel_chk_g
gated_mix__ssm_conv_s5__glu_gated_geglu__prompt_kernel_spin_h:
    s_add_u32 s99, s99, 1
    s_cmp_gt_u32 s99, 40000
    s_cbranch_scc1 gated_mix__ssm_conv_s5__glu_gated_geglu__prompt_kernel_ok_h
    s_sleep 4
    buffer_load_dword v9, v8, s[24:27], 0 offen sc1
    s_waitcnt vmcnt(0)
    s_branch gated_mix__ssm_conv_s5__glu_gated_geglu__prompt_kernel_chk_h
gated_mix__ssm_conv_s5__glu_gated_geglu__prompt_kernel_spin_x:
    s_add_u32 s99, s99, 1
    s_cmp_gt_u32 s99, 40000
    s_cbranch_scc1 gated_mix__ssm_conv_s5__glu_gated_geglu__prompt_kernel_ok_x
    s_sleep 4
    buffer_load_dword v9, v8, s[24:27], 0 offen sc1
    s_waitcnt vmcnt(0)
    s_branch gated_mix__ssm_conv_s5__glu_gated_geglu__prompt_kernel_chk_x
gated_mix__ssm_conv_s5__glu_gated_geglu__prompt_kernel_spin_lb:
    s_add_u32 s99, s99, 1
    s_cmp_gt_u32 s99, 40000
    s_cbranch_scc1 gated_mix__ssm_conv_s5__glu_gated_geglu__prompt_kernel_ok_lb
    s_sleep 4
    v_mov_b32 v27, v23
    buffer_load_dwordx2 v[228:229], v27, s[32:35], 0 offen sc1
    v_add_u32 v27, 0x2000, v27
    buffer_load_dwordx2 v[230:231], v27, s[32:35], 0 offen sc1
    v_add_u32 v27, 0x2000, v27
    buffer_load_dwordx2 v[232:233], v27, s[32:35], 0 offen sc1
    v_add_u32 v27, 0x2000, v27
    buffer_load_dwordx2 v[234:235], v27, s[32:35], 0 offen sc1
    s_waitcnt vmcnt(0)
    s_branch gated_mix__ssm_conv_s5__glu_gated_geglu__prompt_kernel_chk_lb
gated_mix__ssm_conv_s5__glu_gated_geglu__prompt_kernel_codeend:
.section .rodata,"a"
.p2align 6
.amdhsa_kernel gated_mix__ssm_conv_s5__glu_gated_geglu__prompt_kernel
  .amdhsa_next_free_vgpr 512
  .amdhsa_next_free_sgpr 102
  .amdhsa_accum_offset 256
  .amdhsa_group_segment_fixed_size 0
  .amdhsa_kernarg_size 136
  .amdhsa_user_sgpr_count 2
  .amdhsa_user_sgpr_kernarg_segment_ptr 1
  .amdhsa_system_sgpr_workgroup_id_x 1
.end_amdhsa_kernel
```
